```python
import torch

def _softmax(x, axis=-1):
    return torch.softmax(x, dim=axis)
def _gelu(x):
    return torch.nn.functional.gelu(x, approximate="tanh")
def _silu(x):
    return torch.nn.functional.silu(x)
def _sigmoid(x):
    return torch.sigmoid(x)
def _layernorm(x, axis=-1, eps=1e-5):
    m = x.mean(dim=axis, keepdim=True)
    v = x.var(dim=axis, keepdim=True, unbiased=False)
    return (x - m) / torch.sqrt(v + eps)
def _scatter_add(tgt, idx, src, axis=0):
    return tgt.clone().index_add_(axis, idx, src)
def _segment_sum(src, seg, n):
    out = torch.zeros((n,) + src.shape[1:], dtype=src.dtype)
    return out.index_add_(0, seg, src)
def _pad(x, pw):
    flat = tuple(v for pair in reversed(pw) for v in pair)
    return torch.nn.functional.pad(x, flat)

kernel_name = 'standalone__layernorm_linear__sampling'

def setup_inputs():

    _w = (lambda a: (lambda t: t.to(torch.bfloat16) if t.is_floating_point() else t)(torch.as_tensor(a)))
    B, S, D = 1024, 8, 576
    return {
        "x": _w((lambda *s: torch.randn(*s, dtype=torch.bfloat16) * 0.05)(B, S, D)),
        "g": _w((lambda *s: torch.randn(*s, dtype=torch.bfloat16) * 0.05)(D) + 1.0),
        "b": _w((lambda *s: torch.randn(*s, dtype=torch.bfloat16) * 0.4)(D)),
        "w": _w((lambda *s: torch.randn(*s, dtype=torch.bfloat16) * 0.05)(D, D)),
    }

def reference(x, g, b, w):
    return (_layernorm(x, axis=-1) * g + b) @ w
```

```asm
; @launch grid=(256,1,1) block=(768,1,1) lds=159744
.amdgcn_target "amdgcn-amd-amdhsa--gfx950"
.text
.globl standalone__layernorm_linear__sampling_kernel
.p2align 8
.type standalone__layernorm_linear__sampling_kernel,@function
standalone__layernorm_linear__sampling_kernel:
s_cmp_ge_u32 s2, 255
s_cbranch_scc1 L_end
s_load_dwordx8 s[4:11], s[0:1], 0
s_load_dwordx2 s[12:13], s[0:1], 32
v_lshrrev_b32 v2, 6, v0
v_and_b32 v1, 63, v0
s_and_b32 s48, s2, 7
s_lshl_b32 s48, s48, 5
s_lshr_b32 s49, s2, 3
s_add_u32 s48, s48, s49
v_readfirstlane_b32 s36, v2
s_mul_i32 s37, s48, 21846
s_lshr_b32 s37, s37, 16
s_mul_i32 s49, s37, 3
s_sub_u32 s38, s48, s49
s_and_b32 s39, s36, 3
s_mov_b32 s50, 0xffff0000
s_mov_b32 s40, 0
s_mov_b32 s41, 1
s_mov_b32 s42, 2
s_cmp_ge_u32 s36, 8
s_cbranch_scc1 L_mfma
s_lshl_b32 s48, s39, 1
s_add_u32 s49, s39, 8
s_cmp_ge_u32 s36, 4
s_cselect_b32 s47, s48, s49
v_lshrrev_b32 v2, 3, v1
v_and_b32 v2, 2, v2
v_and_b32 v3, 3, v1
v_xor_b32 v2, v2, v3
v_lshrrev_b32 v3, 5, v1
v_lshl_add_u32 v2, v3, 2, v2
v_bfe_u32 v3, v1, 2, 3
v_lshlrev_b32 v5, 4, v2
s_mul_i32 s48, s37, 12
s_add_u32 s48, s48, s47
s_mul_i32 s48, s48, 9216
v_mul_u32_u24 v4, 1152, v3
v_add3_u32 v17, v4, v5, s48
s_mov_b32 s45, 0
s_cmp_ge_u32 s36, 4
s_cbranch_scc1 L_p2
s_cmp_ge_u32 s36, 2
s_cbranch_scc1 L_p1
s_setprio 2
s_waitcnt lgkmcnt(0)
s_mov_b32 s16, s4
s_mov_b32 s17, s5
s_mov_b32 s18, 9437184
s_mov_b32 s19, 0x20000
s_mov_b32 s24, s6
s_mov_b32 s25, s7
s_mov_b32 s26, 1152
s_mov_b32 s27, 0x20000
s_movk_i32 s58, 9216
buffer_load_dwordx4 v[156:159], v5, s[24:27], 0 offen
buffer_load_dwordx4 v[80:83], v17, s[16:19], 0 offen offset:0 sc0 sc1 nt
v_lshlrev_b32 v26, 5, v2
v_add_u32 v26, 122880, v26
s_lshl_b32 s48, s47, 10
s_add_u32 s48, s48, 131072
v_lshlrev_b32 v4, 4, v1
v_add_u32 v19, s48, v4
v_mov_b32 v28, 0
v_mov_b32 v29, 0
v_mov_b32 v30, 0
v_mov_b32 v31, 0
v_mov_b32 v32, 0
v_mov_b32 v33, 0
v_mov_b32 v34, 0
v_mov_b32 v35, 0
buffer_load_dwordx4 v[88:91], v17, s[16:19], 0 offen offset:128 sc0 sc1 nt
buffer_load_dwordx4 v[160:163], v5, s[24:27], 0 offen offset:128
s_mov_b32 s20, s10
s_mov_b32 s21, s11
s_mov_b32 s22, 663552
s_mov_b32 s23, 0x20000
s_mul_i32 s48, s38, 384
s_mul_i32 s49, s36, 36864
s_add_u32 s48, s48, s49
v_add_u32 v6, 0, v1
v_mul_u32_u24 v7, 2731, v6
v_lshrrev_b32 v7, 16, v7
v_mul_u32_u24 v8, 24, v7
v_sub_u32 v6, v6, v8
v_and_b32 v8, 2, v7
v_xor_b32 v6, v6, v8
v_mul_u32_u24 v7, 1152, v7
v_lshl_add_u32 v6, v6, 4, v7
v_add_u32 v11, s48, v6
v_xor_b32 v6, 64, v11
v_add_u32 v14, 9216, v6
v_add_u32 v6, 64, v1
v_mul_u32_u24 v7, 2731, v6
v_lshrrev_b32 v7, 16, v7
v_mul_u32_u24 v8, 24, v7
v_sub_u32 v6, v6, v8
v_and_b32 v8, 2, v7
v_xor_b32 v6, v6, v8
v_mul_u32_u24 v7, 1152, v7
v_lshl_add_u32 v6, v6, 4, v7
v_add_u32 v12, s48, v6
v_xor_b32 v6, 64, v12
v_add_u32 v15, 9216, v6
v_add_u32 v6, 128, v1
v_mul_u32_u24 v7, 2731, v6
v_lshrrev_b32 v7, 16, v7
v_mul_u32_u24 v8, 24, v7
v_sub_u32 v6, v6, v8
v_and_b32 v8, 2, v7
v_xor_b32 v6, v6, v8
v_mul_u32_u24 v7, 1152, v7
v_lshl_add_u32 v6, v6, 4, v7
v_add_u32 v13, s48, v6
v_xor_b32 v6, 64, v13
v_add_u32 v16, 9216, v6
s_mul_i32 s59, s36, 12288
s_mul_i32 s48, s37, 110592
s_mul_i32 s49, s38, 384
s_add_u32 s48, s48, s49
s_mul_i32 s52, s36, 9216
s_add_u32 s48, s48, s52
s_mul_i32 s52, s36, 3264
v_add_u32 v6, 0, v1
v_mul_u32_u24 v7, 2731, v6
v_lshrrev_b32 v7, 16, v7
v_mul_u32_u24 v8, 24, v7
v_sub_u32 v6, v6, v8
v_lshlrev_b32 v6, 4, v6
v_mul_u32_u24 v8, 408, v7
v_add3_u32 v20, v8, v6, s52
v_mul_u32_u24 v8, 1152, v7
v_add3_u32 v23, v8, v6, s48
v_add_u32 v6, 64, v1
v_mul_u32_u24 v7, 2731, v6
v_lshrrev_b32 v7, 16, v7
v_mul_u32_u24 v8, 24, v7
v_sub_u32 v6, v6, v8
v_lshlrev_b32 v6, 4, v6
v_mul_u32_u24 v8, 408, v7
v_add3_u32 v21, v8, v6, s52
v_mul_u32_u24 v8, 1152, v7
v_add3_u32 v24, v8, v6, s48
v_add_u32 v6, 128, v1
v_mul_u32_u24 v7, 2731, v6
v_lshrrev_b32 v7, 16, v7
v_mul_u32_u24 v8, 24, v7
v_sub_u32 v6, v6, v8
v_lshlrev_b32 v6, 4, v6
v_mul_u32_u24 v8, 408, v7
v_add3_u32 v22, v8, v6, s52
v_mul_u32_u24 v8, 1152, v7
v_add3_u32 v25, v8, v6, s48
v_lshlrev_b32 v6, 4, v1
v_add_u32 v164, 39168, v6
s_add_u32 s51, s37, 8160
s_mul_i32 s51, s51, 1152
s_add_u32 s51, s51, s49
v_add_u32 v6, s51, v6
v_mov_b32 v7, 0x40000000
v_cmp_gt_u32 vcc, 24, v1
s_nop 1
v_cndmask_b32 v165, v7, v6, vcc
s_setprio 2
s_waitcnt vmcnt(2)
v_lshlrev_b32 v36, 16, v156
v_and_b32 v37, s50, v156
v_lshlrev_b32 v38, 16, v157
v_and_b32 v39, s50, v157
v_lshlrev_b32 v40, 16, v158
v_and_b32 v41, s50, v158
v_lshlrev_b32 v42, 16, v159
v_and_b32 v43, s50, v159
v_lshlrev_b32 v44, 16, v80
v_and_b32 v45, s50, v80
v_lshlrev_b32 v46, 16, v81
v_and_b32 v47, s50, v81
v_lshlrev_b32 v48, 16, v82
v_and_b32 v49, s50, v82
v_lshlrev_b32 v50, 16, v83
v_and_b32 v51, s50, v83
v_add_f32 v166, v44, v45
v_add_f32 v68, v46, v47
v_add_f32 v166, v166, v48
v_add_f32 v68, v68, v49
v_add_f32 v166, v166, v50
v_add_f32 v68, v68, v51
v_add_f32 v166, v166, v68
s_nop 1
v_add_f32_dpp v166, v166, v166 quad_perm:[1,0,3,2] row_mask:0xf bank_mask:0xf
s_nop 1
v_add_f32_dpp v166, v166, v166 quad_perm:[2,3,0,1] row_mask:0xf bank_mask:0xf
v_mov_b32 v68, v166
s_nop 1
v_permlane32_swap_b32 v166, v68
s_nop 1
v_add_f32 v166, v166, v68
v_mul_f32 v166, 0x3c800000, v166
v_cvt_pk_bf16_f32 v166, v166, v166
v_and_b32 v166, s50, v166
v_pk_add_f32 v[44:45], v[44:45], v[166:167] op_sel:[0,0] op_sel_hi:[1,0] neg_lo:[0,1] neg_hi:[0,1]
v_pk_add_f32 v[46:47], v[46:47], v[166:167] op_sel:[0,0] op_sel_hi:[1,0] neg_lo:[0,1] neg_hi:[0,1]
v_pk_add_f32 v[48:49], v[48:49], v[166:167] op_sel:[0,0] op_sel_hi:[1,0] neg_lo:[0,1] neg_hi:[0,1]
v_pk_add_f32 v[50:51], v[50:51], v[166:167] op_sel:[0,0] op_sel_hi:[1,0] neg_lo:[0,1] neg_hi:[0,1]
v_pk_mul_f32 v[144:145], v[44:45], v[36:37]
v_pk_mul_f32 v[146:147], v[46:47], v[38:39]
v_pk_mul_f32 v[148:149], v[48:49], v[40:41]
v_pk_mul_f32 v[150:151], v[50:51], v[42:43]
v_cvt_pk_bf16_f32 v72, v144, v145
v_cvt_pk_bf16_f32 v73, v146, v147
v_cvt_pk_bf16_f32 v74, v148, v149
v_cvt_pk_bf16_f32 v75, v150, v151
ds_write_b128 v19, v[72:75] offset:0
v_pk_add_f32 v[28:29], v[28:29], v[44:45]
v_pk_fma_f32 v[30:31], v[44:45], v[44:45], v[30:31]
v_pk_add_f32 v[28:29], v[28:29], v[46:47]
v_pk_fma_f32 v[30:31], v[46:47], v[46:47], v[30:31]
v_pk_add_f32 v[28:29], v[28:29], v[48:49]
v_pk_fma_f32 v[30:31], v[48:49], v[48:49], v[30:31]
v_pk_add_f32 v[28:29], v[28:29], v[50:51]
v_pk_fma_f32 v[30:31], v[50:51], v[50:51], v[30:31]
s_waitcnt lgkmcnt(0)
s_barrier
s_setprio 2
s_mov_b32 s57, 147456
s_add_u32 m0, s59, 49152
s_nop 0
buffer_load_dwordx4 v11, s[20:23], s57 offen lds
buffer_load_dwordx4 v[96:99], v17, s[16:19], 0 offen offset:256 sc0 sc1 nt
buffer_load_dwordx4 v[104:107], v17, s[16:19], 0 offen offset:384 sc0 sc1 nt
s_waitcnt vmcnt(3)
v_lshlrev_b32 v36, 16, v160
s_add_u32 m0, s59, 50176
v_and_b32 v37, s50, v160
buffer_load_dwordx4 v12, s[20:23], s57 offen lds
v_lshlrev_b32 v38, 16, v161
v_and_b32 v39, s50, v161
v_lshlrev_b32 v40, 16, v162
s_add_u32 m0, s59, 51200
v_and_b32 v41, s50, v162
buffer_load_dwordx4 v13, s[20:23], s57 offen lds
v_lshlrev_b32 v42, 16, v163
v_and_b32 v43, s50, v163
s_waitcnt vmcnt(6)
v_lshlrev_b32 v44, 16, v88
s_add_u32 m0, s59, 52224
v_and_b32 v45, s50, v88
buffer_load_dwordx4 v14, s[20:23], s57 offen lds
v_lshlrev_b32 v46, 16, v89
v_and_b32 v47, s50, v89
v_lshlrev_b32 v48, 16, v90
s_add_u32 m0, s59, 53248
v_and_b32 v49, s50, v90
buffer_load_dwordx4 v15, s[20:23], s57 offen lds
v_lshlrev_b32 v50, 16, v91
v_and_b32 v51, s50, v91
v_sub_f32 v44, v44, v166
s_add_u32 m0, s59, 54272
v_sub_f32 v45, v45, v166
buffer_load_dwordx4 v16, s[20:23], s57 offen lds
v_sub_f32 v46, v46, v166
v_sub_f32 v47, v47, v166
v_sub_f32 v48, v48, v166
v_sub_f32 v49, v49, v166
s_mov_b32 s57, 165888
s_add_u32 m0, s59, 55296
v_sub_f32 v50, v50, v166
buffer_load_dwordx4 v11, s[20:23], s57 offen lds
v_sub_f32 v51, v51, v166
v_mul_f32 v68, v44, v36
v_mul_f32 v69, v45, v37
s_add_u32 m0, s59, 56320
v_cvt_pk_bf16_f32 v72, v68, v69
buffer_load_dwordx4 v12, s[20:23], s57 offen lds
v_mul_f32 v70, v46, v38
v_mul_f32 v71, v47, v39
v_cvt_pk_bf16_f32 v73, v70, v71
s_add_u32 m0, s59, 57344
v_mul_f32 v68, v48, v40
buffer_load_dwordx4 v13, s[20:23], s57 offen lds
v_mul_f32 v69, v49, v41
v_cvt_pk_bf16_f32 v74, v68, v69
v_mul_f32 v70, v50, v42
v_mul_f32 v71, v51, v43
s_add_u32 m0, s59, 58368
v_cvt_pk_bf16_f32 v75, v70, v71
buffer_load_dwordx4 v14, s[20:23], s57 offen lds
ds_write_b128 v19, v[72:75] offset:16384
ds_read_b128 v[36:39], v26 offset:512
ds_read_b128 v[40:43], v26 offset:528
s_add_u32 m0, s59, 59392
s_nop 0
buffer_load_dwordx4 v15, s[20:23], s57 offen lds
v_pk_add_f32 v[28:29], v[28:29], v[44:45]
v_pk_fma_f32 v[30:31], v[44:45], v[44:45], v[30:31]
v_pk_add_f32 v[28:29], v[28:29], v[46:47]
s_add_u32 m0, s59, 60416
v_pk_fma_f32 v[30:31], v[46:47], v[46:47], v[30:31]
buffer_load_dwordx4 v16, s[20:23], s57 offen lds
v_pk_add_f32 v[28:29], v[28:29], v[48:49]
v_pk_fma_f32 v[30:31], v[48:49], v[48:49], v[30:31]
v_pk_add_f32 v[28:29], v[28:29], v[50:51]
v_pk_fma_f32 v[30:31], v[50:51], v[50:51], v[30:31]
s_waitcnt vmcnt(63)
s_waitcnt lgkmcnt(0)
s_barrier
s_setprio 2
s_mov_b32 s57, 221184
s_add_u32 m0, s59, 73728
s_nop 0
buffer_load_dwordx4 v11, s[20:23], s57 offen lds
s_waitcnt vmcnt(13)
v_lshlrev_b32 v44, 16, v96
v_and_b32 v45, s50, v96
s_add_u32 m0, s59, 74752
v_lshlrev_b32 v46, 16, v97
buffer_load_dwordx4 v12, s[20:23], s57 offen lds
v_and_b32 v47, s50, v97
v_lshlrev_b32 v48, 16, v98
v_and_b32 v49, s50, v98
s_add_u32 m0, s59, 75776
v_lshlrev_b32 v50, 16, v99
buffer_load_dwordx4 v13, s[20:23], s57 offen lds
v_and_b32 v51, s50, v99
v_sub_f32 v44, v44, v166
s_add_u32 m0, s59, 76800
v_sub_f32 v45, v45, v166
buffer_load_dwordx4 v14, s[20:23], s57 offen lds
v_sub_f32 v46, v46, v166
v_sub_f32 v47, v47, v166
v_sub_f32 v48, v48, v166
s_add_u32 m0, s59, 77824
v_sub_f32 v49, v49, v166
buffer_load_dwordx4 v15, s[20:23], s57 offen lds
v_sub_f32 v50, v50, v166
v_sub_f32 v51, v51, v166
s_add_u32 m0, s59, 78848
s_nop 0
buffer_load_dwordx4 v16, s[20:23], s57 offen lds
buffer_load_dwordx4 v[112:115], v17, s[16:19], 0 offen offset:512 sc0 sc1 nt
v_mul_f32 v68, v44, v36
v_mul_f32 v69, v45, v37
v_cvt_pk_bf16_f32 v72, v68, v69
s_mov_b32 s57, 239616
s_add_u32 m0, s59, 79872
v_mul_f32 v70, v46, v38
buffer_load_dwordx4 v11, s[20:23], s57 offen lds
v_mul_f32 v71, v47, v39
v_cvt_pk_bf16_f32 v73, v70, v71
s_add_u32 m0, s59, 80896
v_mul_f32 v68, v48, v40
buffer_load_dwordx4 v12, s[20:23], s57 offen lds
v_mul_f32 v69, v49, v41
v_cvt_pk_bf16_f32 v74, v68, v69
v_mul_f32 v70, v50, v42
s_add_u32 m0, s59, 81920
v_mul_f32 v71, v51, v43
buffer_load_dwordx4 v13, s[20:23], s57 offen lds
v_cvt_pk_bf16_f32 v75, v70, v71
ds_write_b128 v19, v[72:75] offset:0
s_add_u32 m0, s59, 82944
s_nop 0
buffer_load_dwordx4 v14, s[20:23], s57 offen lds
ds_read_b128 v[36:39], v26 offset:768
ds_read_b128 v[40:43], v26 offset:784
v_pk_add_f32 v[28:29], v[28:29], v[44:45]
s_add_u32 m0, s59, 83968
v_pk_fma_f32 v[30:31], v[44:45], v[44:45], v[30:31]
buffer_load_dwordx4 v15, s[20:23], s57 offen lds
v_pk_add_f32 v[28:29], v[28:29], v[46:47]
v_pk_fma_f32 v[30:31], v[46:47], v[46:47], v[30:31]
s_add_u32 m0, s59, 84992
v_pk_add_f32 v[28:29], v[28:29], v[48:49]
buffer_load_dwordx4 v16, s[20:23], s57 offen lds
v_pk_fma_f32 v[30:31], v[48:49], v[48:49], v[30:31]
v_pk_add_f32 v[28:29], v[28:29], v[50:51]
v_pk_fma_f32 v[30:31], v[50:51], v[50:51], v[30:31]
s_waitcnt vmcnt(13)
s_waitcnt lgkmcnt(0)
s_barrier
s_setprio 2
s_mov_b32 s57, 294912
s_add_u32 m0, s59, 98304
s_nop 0
buffer_load_dwordx4 v11, s[20:23], s57 offen lds
s_waitcnt vmcnt(25)
v_lshlrev_b32 v44, 16, v104
v_and_b32 v45, s50, v104
s_add_u32 m0, s59, 99328
v_lshlrev_b32 v46, 16, v105
buffer_load_dwordx4 v12, s[20:23], s57 offen lds
v_and_b32 v47, s50, v105
v_lshlrev_b32 v48, 16, v106
v_and_b32 v49, s50, v106
s_add_u32 m0, s59, 100352
v_lshlrev_b32 v50, 16, v107
buffer_load_dwordx4 v13, s[20:23], s57 offen lds
v_and_b32 v51, s50, v107
v_sub_f32 v44, v44, v166
s_add_u32 m0, s59, 101376
v_sub_f32 v45, v45, v166
buffer_load_dwordx4 v14, s[20:23], s57 offen lds
v_sub_f32 v46, v46, v166
v_sub_f32 v47, v47, v166
v_sub_f32 v48, v48, v166
s_add_u32 m0, s59, 102400
v_sub_f32 v49, v49, v166
buffer_load_dwordx4 v15, s[20:23], s57 offen lds
v_sub_f32 v50, v50, v166
v_sub_f32 v51, v51, v166
s_add_u32 m0, s59, 103424
s_nop 0
buffer_load_dwordx4 v16, s[20:23], s57 offen lds
buffer_load_dwordx4 v[120:123], v17, s[16:19], 0 offen offset:640 sc0 sc1 nt
v_mul_f32 v68, v44, v36
v_mul_f32 v69, v45, v37
v_cvt_pk_bf16_f32 v72, v68, v69
s_mov_b32 s57, 313344
s_add_u32 m0, s59, 104448
v_mul_f32 v70, v46, v38
buffer_load_dwordx4 v11, s[20:23], s57 offen lds
v_mul_f32 v71, v47, v39
v_cvt_pk_bf16_f32 v73, v70, v71
s_add_u32 m0, s59, 105472
v_mul_f32 v68, v48, v40
buffer_load_dwordx4 v12, s[20:23], s57 offen lds
v_mul_f32 v69, v49, v41
v_cvt_pk_bf16_f32 v74, v68, v69
v_mul_f32 v70, v50, v42
s_add_u32 m0, s59, 106496
v_mul_f32 v71, v51, v43
buffer_load_dwordx4 v13, s[20:23], s57 offen lds
v_cvt_pk_bf16_f32 v75, v70, v71
ds_write_b128 v19, v[72:75] offset:16384
s_add_u32 m0, s59, 107520
s_nop 0
buffer_load_dwordx4 v14, s[20:23], s57 offen lds
ds_read_b128 v[36:39], v26 offset:1024
ds_read_b128 v[40:43], v26 offset:1040
v_pk_add_f32 v[28:29], v[28:29], v[44:45]
s_add_u32 m0, s59, 108544
v_pk_fma_f32 v[30:31], v[44:45], v[44:45], v[30:31]
buffer_load_dwordx4 v15, s[20:23], s57 offen lds
v_pk_add_f32 v[28:29], v[28:29], v[46:47]
v_pk_fma_f32 v[30:31], v[46:47], v[46:47], v[30:31]
s_add_u32 m0, s59, 109568
v_pk_add_f32 v[28:29], v[28:29], v[48:49]
buffer_load_dwordx4 v16, s[20:23], s57 offen lds
v_pk_fma_f32 v[30:31], v[48:49], v[48:49], v[30:31]
v_pk_add_f32 v[28:29], v[28:29], v[50:51]
v_pk_fma_f32 v[30:31], v[50:51], v[50:51], v[30:31]
s_waitcnt vmcnt(13)
s_waitcnt lgkmcnt(0)
s_barrier
s_setprio 2
s_mov_b32 s57, 368640
s_add_u32 m0, s59, 0
s_nop 0
buffer_load_dwordx4 v11, s[20:23], s57 offen lds
s_waitcnt vmcnt(20)
v_lshlrev_b32 v44, 16, v112
v_and_b32 v45, s50, v112
s_add_u32 m0, s59, 1024
v_lshlrev_b32 v46, 16, v113
buffer_load_dwordx4 v12, s[20:23], s57 offen lds
v_and_b32 v47, s50, v113
v_lshlrev_b32 v48, 16, v114
v_and_b32 v49, s50, v114
s_add_u32 m0, s59, 2048
v_lshlrev_b32 v50, 16, v115
buffer_load_dwordx4 v13, s[20:23], s57 offen lds
v_and_b32 v51, s50, v115
v_sub_f32 v44, v44, v166
s_add_u32 m0, s59, 3072
v_sub_f32 v45, v45, v166
buffer_load_dwordx4 v14, s[20:23], s57 offen lds
v_sub_f32 v46, v46, v166
v_sub_f32 v47, v47, v166
v_sub_f32 v48, v48, v166
s_add_u32 m0, s59, 4096
v_sub_f32 v49, v49, v166
buffer_load_dwordx4 v15, s[20:23], s57 offen lds
v_sub_f32 v50, v50, v166
v_sub_f32 v51, v51, v166
s_add_u32 m0, s59, 5120
s_nop 0
buffer_load_dwordx4 v16, s[20:23], s57 offen lds
buffer_load_dwordx4 v[128:131], v17, s[16:19], 0 offen offset:768 sc0 sc1 nt
v_mul_f32 v68, v44, v36
v_mul_f32 v69, v45, v37
v_cvt_pk_bf16_f32 v72, v68, v69
s_mov_b32 s57, 387072
s_add_u32 m0, s59, 6144
v_mul_f32 v70, v46, v38
buffer_load_dwordx4 v11, s[20:23], s57 offen lds
v_mul_f32 v71, v47, v39
v_cvt_pk_bf16_f32 v73, v70, v71
s_add_u32 m0, s59, 7168
v_mul_f32 v68, v48, v40
buffer_load_dwordx4 v12, s[20:23], s57 offen lds
v_mul_f32 v69, v49, v41
v_cvt_pk_bf16_f32 v74, v68, v69
v_mul_f32 v70, v50, v42
s_add_u32 m0, s59, 8192
v_mul_f32 v71, v51, v43
buffer_load_dwordx4 v13, s[20:23], s57 offen lds
v_cvt_pk_bf16_f32 v75, v70, v71
ds_write_b128 v19, v[72:75] offset:0
s_add_u32 m0, s59, 9216
s_nop 0
buffer_load_dwordx4 v14, s[20:23], s57 offen lds
ds_read_b128 v[36:39], v26 offset:1280
ds_read_b128 v[40:43], v26 offset:1296
v_pk_add_f32 v[28:29], v[28:29], v[44:45]
s_add_u32 m0, s59, 10240
v_pk_fma_f32 v[30:31], v[44:45], v[44:45], v[30:31]
buffer_load_dwordx4 v15, s[20:23], s57 offen lds
v_pk_add_f32 v[28:29], v[28:29], v[46:47]
v_pk_fma_f32 v[30:31], v[46:47], v[46:47], v[30:31]
s_add_u32 m0, s59, 11264
v_pk_add_f32 v[28:29], v[28:29], v[48:49]
buffer_load_dwordx4 v16, s[20:23], s57 offen lds
v_pk_fma_f32 v[30:31], v[48:49], v[48:49], v[30:31]
v_pk_add_f32 v[28:29], v[28:29], v[50:51]
v_pk_fma_f32 v[30:31], v[50:51], v[50:51], v[30:31]
s_waitcnt vmcnt(13)
s_waitcnt lgkmcnt(0)
s_barrier
s_setprio 2
s_mov_b32 s57, 442368
s_add_u32 m0, s59, 24576
s_nop 0
buffer_load_dwordx4 v11, s[20:23], s57 offen lds
s_waitcnt vmcnt(20)
v_lshlrev_b32 v44, 16, v120
v_and_b32 v45, s50, v120
s_add_u32 m0, s59, 25600
v_lshlrev_b32 v46, 16, v121
buffer_load_dwordx4 v12, s[20:23], s57 offen lds
v_and_b32 v47, s50, v121
v_lshlrev_b32 v48, 16, v122
v_and_b32 v49, s50, v122
s_add_u32 m0, s59, 26624
v_lshlrev_b32 v50, 16, v123
buffer_load_dwordx4 v13, s[20:23], s57 offen lds
v_and_b32 v51, s50, v123
v_sub_f32 v44, v44, v166
s_add_u32 m0, s59, 27648
v_sub_f32 v45, v45, v166
buffer_load_dwordx4 v14, s[20:23], s57 offen lds
v_sub_f32 v46, v46, v166
v_sub_f32 v47, v47, v166
v_sub_f32 v48, v48, v166
s_add_u32 m0, s59, 28672
v_sub_f32 v49, v49, v166
buffer_load_dwordx4 v15, s[20:23], s57 offen lds
v_sub_f32 v50, v50, v166
v_sub_f32 v51, v51, v166
s_add_u32 m0, s59, 29696
s_nop 0
buffer_load_dwordx4 v16, s[20:23], s57 offen lds
buffer_load_dwordx4 v[136:139], v17, s[16:19], 0 offen offset:896 sc0 sc1 nt
v_mul_f32 v68, v44, v36
v_mul_f32 v69, v45, v37
v_cvt_pk_bf16_f32 v72, v68, v69
s_mov_b32 s57, 460800
s_add_u32 m0, s59, 30720
v_mul_f32 v70, v46, v38
buffer_load_dwordx4 v11, s[20:23], s57 offen lds
v_mul_f32 v71, v47, v39
v_cvt_pk_bf16_f32 v73, v70, v71
s_add_u32 m0, s59, 31744
v_mul_f32 v68, v48, v40
buffer_load_dwordx4 v12, s[20:23], s57 offen lds
v_mul_f32 v69, v49, v41
v_cvt_pk_bf16_f32 v74, v68, v69
v_mul_f32 v70, v50, v42
s_add_u32 m0, s59, 32768
v_mul_f32 v71, v51, v43
buffer_load_dwordx4 v13, s[20:23], s57 offen lds
v_cvt_pk_bf16_f32 v75, v70, v71
ds_write_b128 v19, v[72:75] offset:16384
s_add_u32 m0, s59, 33792
s_nop 0
buffer_load_dwordx4 v14, s[20:23], s57 offen lds
ds_read_b128 v[36:39], v26 offset:1536
ds_read_b128 v[40:43], v26 offset:1552
v_pk_add_f32 v[28:29], v[28:29], v[44:45]
s_add_u32 m0, s59, 34816
v_pk_fma_f32 v[30:31], v[44:45], v[44:45], v[30:31]
buffer_load_dwordx4 v15, s[20:23], s57 offen lds
v_pk_add_f32 v[28:29], v[28:29], v[46:47]
v_pk_fma_f32 v[30:31], v[46:47], v[46:47], v[30:31]
s_add_u32 m0, s59, 35840
v_pk_add_f32 v[28:29], v[28:29], v[48:49]
buffer_load_dwordx4 v16, s[20:23], s57 offen lds
v_pk_fma_f32 v[30:31], v[48:49], v[48:49], v[30:31]
v_pk_add_f32 v[28:29], v[28:29], v[50:51]
v_pk_fma_f32 v[30:31], v[50:51], v[50:51], v[30:31]
s_waitcnt vmcnt(13)
s_waitcnt lgkmcnt(0)
s_barrier
s_setprio 2
s_mov_b32 s57, 516096
s_add_u32 m0, s59, 49152
s_nop 0
buffer_load_dwordx4 v11, s[20:23], s57 offen lds
s_waitcnt vmcnt(20)
v_lshlrev_b32 v44, 16, v128
v_and_b32 v45, s50, v128
s_add_u32 m0, s59, 50176
v_lshlrev_b32 v46, 16, v129
buffer_load_dwordx4 v12, s[20:23], s57 offen lds
v_and_b32 v47, s50, v129
v_lshlrev_b32 v48, 16, v130
v_and_b32 v49, s50, v130
s_add_u32 m0, s59, 51200
v_lshlrev_b32 v50, 16, v131
buffer_load_dwordx4 v13, s[20:23], s57 offen lds
v_and_b32 v51, s50, v131
v_sub_f32 v44, v44, v166
s_add_u32 m0, s59, 52224
v_sub_f32 v45, v45, v166
buffer_load_dwordx4 v14, s[20:23], s57 offen lds
v_sub_f32 v46, v46, v166
v_sub_f32 v47, v47, v166
v_sub_f32 v48, v48, v166
s_add_u32 m0, s59, 53248
v_sub_f32 v49, v49, v166
buffer_load_dwordx4 v15, s[20:23], s57 offen lds
v_sub_f32 v50, v50, v166
v_sub_f32 v51, v51, v166
s_add_u32 m0, s59, 54272
s_nop 0
buffer_load_dwordx4 v16, s[20:23], s57 offen lds
buffer_load_dwordx4 v[144:147], v17, s[16:19], 0 offen offset:1024 sc0 sc1 nt
v_mul_f32 v68, v44, v36
v_mul_f32 v69, v45, v37
v_cvt_pk_bf16_f32 v72, v68, v69
s_mov_b32 s57, 534528
s_add_u32 m0, s59, 55296
v_mul_f32 v70, v46, v38
buffer_load_dwordx4 v11, s[20:23], s57 offen lds
v_mul_f32 v71, v47, v39
v_cvt_pk_bf16_f32 v73, v70, v71
s_add_u32 m0, s59, 56320
v_mul_f32 v68, v48, v40
buffer_load_dwordx4 v12, s[20:23], s57 offen lds
v_mul_f32 v69, v49, v41
v_cvt_pk_bf16_f32 v74, v68, v69
v_mul_f32 v70, v50, v42
s_add_u32 m0, s59, 57344
v_mul_f32 v71, v51, v43
buffer_load_dwordx4 v13, s[20:23], s57 offen lds
v_cvt_pk_bf16_f32 v75, v70, v71
ds_write_b128 v19, v[72:75] offset:0
s_add_u32 m0, s59, 58368
s_nop 0
buffer_load_dwordx4 v14, s[20:23], s57 offen lds
ds_read_b128 v[36:39], v26 offset:1792
ds_read_b128 v[40:43], v26 offset:1808
v_pk_add_f32 v[28:29], v[28:29], v[44:45]
s_add_u32 m0, s59, 59392
v_pk_fma_f32 v[30:31], v[44:45], v[44:45], v[30:31]
buffer_load_dwordx4 v15, s[20:23], s57 offen lds
v_pk_add_f32 v[28:29], v[28:29], v[46:47]
v_pk_fma_f32 v[30:31], v[46:47], v[46:47], v[30:31]
s_add_u32 m0, s59, 60416
v_pk_add_f32 v[28:29], v[28:29], v[48:49]
buffer_load_dwordx4 v16, s[20:23], s57 offen lds
v_pk_fma_f32 v[30:31], v[48:49], v[48:49], v[30:31]
v_pk_add_f32 v[28:29], v[28:29], v[50:51]
v_pk_fma_f32 v[30:31], v[50:51], v[50:51], v[30:31]
s_waitcnt vmcnt(13)
s_waitcnt lgkmcnt(0)
s_barrier
s_setprio 2
s_mov_b32 s57, 589824
s_add_u32 m0, s59, 73728
s_nop 0
buffer_load_dwordx4 v11, s[20:23], s57 offen lds
s_waitcnt vmcnt(20)
v_lshlrev_b32 v44, 16, v136
v_and_b32 v45, s50, v136
s_add_u32 m0, s59, 74752
v_lshlrev_b32 v46, 16, v137
buffer_load_dwordx4 v12, s[20:23], s57 offen lds
v_and_b32 v47, s50, v137
v_lshlrev_b32 v48, 16, v138
s_add_u32 m0, s59, 75776
v_and_b32 v49, s50, v138
buffer_load_dwordx4 v13, s[20:23], s57 offen lds
v_lshlrev_b32 v50, 16, v139
v_and_b32 v51, s50, v139
v_sub_f32 v44, v44, v166
s_add_u32 m0, s59, 76800
v_sub_f32 v45, v45, v166
buffer_load_dwordx4 v14, s[20:23], s57 offen lds
v_sub_f32 v46, v46, v166
v_sub_f32 v47, v47, v166
s_add_u32 m0, s59, 77824
v_sub_f32 v48, v48, v166
buffer_load_dwordx4 v15, s[20:23], s57 offen lds
v_sub_f32 v49, v49, v166
v_sub_f32 v50, v50, v166
v_sub_f32 v51, v51, v166
s_add_u32 m0, s59, 78848
v_mul_f32 v68, v44, v36
buffer_load_dwordx4 v16, s[20:23], s57 offen lds
v_mul_f32 v69, v45, v37
v_cvt_pk_bf16_f32 v72, v68, v69
s_mov_b32 s57, 608256
s_add_u32 m0, s59, 79872
v_mul_f32 v70, v46, v38
buffer_load_dwordx4 v11, s[20:23], s57 offen lds
v_mul_f32 v71, v47, v39
v_cvt_pk_bf16_f32 v73, v70, v71
s_add_u32 m0, s59, 80896
v_mul_f32 v68, v48, v40
buffer_load_dwordx4 v12, s[20:23], s57 offen lds
v_mul_f32 v69, v49, v41
v_cvt_pk_bf16_f32 v74, v68, v69
v_mul_f32 v70, v50, v42
s_add_u32 m0, s59, 81920
v_mul_f32 v71, v51, v43
buffer_load_dwordx4 v13, s[20:23], s57 offen lds
v_cvt_pk_bf16_f32 v75, v70, v71
ds_write_b128 v19, v[72:75] offset:16384
s_add_u32 m0, s59, 82944
s_nop 0
buffer_load_dwordx4 v14, s[20:23], s57 offen lds
ds_read_b128 v[36:39], v26 offset:2048
ds_read_b128 v[40:43], v26 offset:2064
v_pk_add_f32 v[28:29], v[28:29], v[44:45]
s_add_u32 m0, s59, 83968
v_pk_fma_f32 v[30:31], v[44:45], v[44:45], v[30:31]
buffer_load_dwordx4 v15, s[20:23], s57 offen lds
v_pk_add_f32 v[28:29], v[28:29], v[46:47]
v_pk_fma_f32 v[30:31], v[46:47], v[46:47], v[30:31]
s_add_u32 m0, s59, 84992
v_pk_add_f32 v[28:29], v[28:29], v[48:49]
buffer_load_dwordx4 v16, s[20:23], s57 offen lds
v_pk_fma_f32 v[30:31], v[48:49], v[48:49], v[30:31]
v_pk_add_f32 v[28:29], v[28:29], v[50:51]
v_pk_fma_f32 v[30:31], v[50:51], v[50:51], v[30:31]
s_waitcnt vmcnt(12)
s_waitcnt lgkmcnt(0)
s_barrier
s_setprio 2
s_waitcnt vmcnt(18)
v_lshlrev_b32 v44, 16, v144
v_and_b32 v45, s50, v144
v_lshlrev_b32 v46, 16, v145
v_and_b32 v47, s50, v145
v_lshlrev_b32 v48, 16, v146
v_and_b32 v49, s50, v146
v_lshlrev_b32 v50, 16, v147
v_and_b32 v51, s50, v147
v_sub_f32 v44, v44, v166
v_sub_f32 v45, v45, v166
v_sub_f32 v46, v46, v166
v_sub_f32 v47, v47, v166
v_sub_f32 v48, v48, v166
v_sub_f32 v49, v49, v166
v_sub_f32 v50, v50, v166
v_sub_f32 v51, v51, v166
v_mul_f32 v68, v44, v36
v_mul_f32 v69, v45, v37
v_cvt_pk_bf16_f32 v72, v68, v69
v_mul_f32 v70, v46, v38
v_mul_f32 v71, v47, v39
v_cvt_pk_bf16_f32 v73, v70, v71
v_mul_f32 v68, v48, v40
v_mul_f32 v69, v49, v41
v_cvt_pk_bf16_f32 v74, v68, v69
v_mul_f32 v70, v50, v42
v_mul_f32 v71, v51, v43
v_cvt_pk_bf16_f32 v75, v70, v71
ds_write_b128 v19, v[72:75] offset:0
v_pk_add_f32 v[28:29], v[28:29], v[44:45]
v_pk_fma_f32 v[30:31], v[44:45], v[44:45], v[30:31]
v_pk_add_f32 v[28:29], v[28:29], v[46:47]
v_pk_fma_f32 v[30:31], v[46:47], v[46:47], v[30:31]
v_pk_add_f32 v[28:29], v[28:29], v[48:49]
v_pk_fma_f32 v[30:31], v[48:49], v[48:49], v[30:31]
v_pk_add_f32 v[28:29], v[28:29], v[50:51]
v_pk_fma_f32 v[30:31], v[50:51], v[50:51], v[30:31]
s_waitcnt vmcnt(0)
s_waitcnt lgkmcnt(0)
s_barrier
s_setprio 3
s_branch L_pstats
L_p1:
s_waitcnt lgkmcnt(0)
s_mov_b32 s16, s4
s_mov_b32 s17, s5
s_mov_b32 s18, 9437184
s_mov_b32 s19, 0x20000
s_mov_b32 s24, s6
s_mov_b32 s25, s7
s_mov_b32 s26, 1152
s_mov_b32 s27, 0x20000
s_movk_i32 s58, 9216
buffer_load_dwordx4 v[156:159], v5, s[24:27], 0 offen
buffer_load_dwordx4 v[80:83], v17, s[16:19], 0 offen offset:0 sc0 sc1 nt
v_lshlrev_b32 v26, 5, v2
v_add_u32 v26, 122880, v26
s_lshl_b32 s48, s47, 10
s_add_u32 s48, s48, 131072
v_lshlrev_b32 v4, 4, v1
v_add_u32 v19, s48, v4
v_mov_b32 v28, 0
v_mov_b32 v29, 0
v_mov_b32 v30, 0
v_mov_b32 v31, 0
v_mov_b32 v32, 0
v_mov_b32 v33, 0
v_mov_b32 v34, 0
v_mov_b32 v35, 0
buffer_load_dwordx4 v[88:91], v17, s[16:19], 0 offen offset:128 sc0 sc1 nt
buffer_load_dwordx4 v[160:163], v5, s[24:27], 0 offen offset:128
s_mul_i32 s48, s37, 110592
s_mul_i32 s49, s38, 384
s_add_u32 s48, s48, s49
s_mul_i32 s52, s36, 9216
s_add_u32 s48, s48, s52
s_mul_i32 s52, s36, 3264
v_add_u32 v6, 0, v1
v_mul_u32_u24 v7, 2731, v6
v_lshrrev_b32 v7, 16, v7
v_mul_u32_u24 v8, 24, v7
v_sub_u32 v6, v6, v8
v_lshlrev_b32 v6, 4, v6
v_mul_u32_u24 v8, 408, v7
v_add3_u32 v20, v8, v6, s52
v_mul_u32_u24 v8, 1152, v7
v_add3_u32 v23, v8, v6, s48
v_add_u32 v6, 64, v1
v_mul_u32_u24 v7, 2731, v6
v_lshrrev_b32 v7, 16, v7
v_mul_u32_u24 v8, 24, v7
v_sub_u32 v6, v6, v8
v_lshlrev_b32 v6, 4, v6
v_mul_u32_u24 v8, 408, v7
v_add3_u32 v21, v8, v6, s52
v_mul_u32_u24 v8, 1152, v7
v_add3_u32 v24, v8, v6, s48
v_add_u32 v6, 128, v1
v_mul_u32_u24 v7, 2731, v6
v_lshrrev_b32 v7, 16, v7
v_mul_u32_u24 v8, 24, v7
v_sub_u32 v6, v6, v8
v_lshlrev_b32 v6, 4, v6
v_mul_u32_u24 v8, 408, v7
v_add3_u32 v22, v8, v6, s52
v_mul_u32_u24 v8, 1152, v7
v_add3_u32 v25, v8, v6, s48
v_lshlrev_b32 v6, 4, v1
v_add_u32 v164, 39168, v6
s_add_u32 s51, s37, 8160
s_mul_i32 s51, s51, 1152
s_add_u32 s51, s51, s49
v_add_u32 v6, s51, v6
v_mov_b32 v7, 0x40000000
v_cmp_gt_u32 vcc, 24, v1
s_nop 1
v_cndmask_b32 v165, v7, v6, vcc
s_setprio 1
s_waitcnt vmcnt(2)
v_lshlrev_b32 v36, 16, v156
v_and_b32 v37, s50, v156
v_lshlrev_b32 v38, 16, v157
v_and_b32 v39, s50, v157
v_lshlrev_b32 v40, 16, v158
v_and_b32 v41, s50, v158
v_lshlrev_b32 v42, 16, v159
v_and_b32 v43, s50, v159
v_lshlrev_b32 v44, 16, v80
v_and_b32 v45, s50, v80
v_lshlrev_b32 v46, 16, v81
v_and_b32 v47, s50, v81
v_lshlrev_b32 v48, 16, v82
v_and_b32 v49, s50, v82
v_lshlrev_b32 v50, 16, v83
v_and_b32 v51, s50, v83
v_add_f32 v166, v44, v45
v_add_f32 v68, v46, v47
v_add_f32 v166, v166, v48
v_add_f32 v68, v68, v49
v_add_f32 v166, v166, v50
v_add_f32 v68, v68, v51
v_add_f32 v166, v166, v68
s_nop 1
v_add_f32_dpp v166, v166, v166 quad_perm:[1,0,3,2] row_mask:0xf bank_mask:0xf
s_nop 1
v_add_f32_dpp v166, v166, v166 quad_perm:[2,3,0,1] row_mask:0xf bank_mask:0xf
v_mov_b32 v68, v166
s_nop 1
v_permlane32_swap_b32 v166, v68
s_nop 1
v_add_f32 v166, v166, v68
v_mul_f32 v166, 0x3c800000, v166
v_cvt_pk_bf16_f32 v166, v166, v166
v_and_b32 v166, s50, v166
v_pk_add_f32 v[44:45], v[44:45], v[166:167] op_sel:[0,0] op_sel_hi:[1,0] neg_lo:[0,1] neg_hi:[0,1]
v_pk_add_f32 v[46:47], v[46:47], v[166:167] op_sel:[0,0] op_sel_hi:[1,0] neg_lo:[0,1] neg_hi:[0,1]
v_pk_add_f32 v[48:49], v[48:49], v[166:167] op_sel:[0,0] op_sel_hi:[1,0] neg_lo:[0,1] neg_hi:[0,1]
v_pk_add_f32 v[50:51], v[50:51], v[166:167] op_sel:[0,0] op_sel_hi:[1,0] neg_lo:[0,1] neg_hi:[0,1]
v_pk_mul_f32 v[144:145], v[44:45], v[36:37]
v_pk_mul_f32 v[146:147], v[46:47], v[38:39]
v_pk_mul_f32 v[148:149], v[48:49], v[40:41]
v_pk_mul_f32 v[150:151], v[50:51], v[42:43]
v_cvt_pk_bf16_f32 v72, v144, v145
v_cvt_pk_bf16_f32 v73, v146, v147
v_cvt_pk_bf16_f32 v74, v148, v149
v_cvt_pk_bf16_f32 v75, v150, v151
ds_write_b128 v19, v[72:75] offset:0
v_pk_add_f32 v[28:29], v[28:29], v[44:45]
v_pk_fma_f32 v[30:31], v[44:45], v[44:45], v[30:31]
v_pk_add_f32 v[28:29], v[28:29], v[46:47]
v_pk_fma_f32 v[30:31], v[46:47], v[46:47], v[30:31]
v_pk_add_f32 v[28:29], v[28:29], v[48:49]
v_pk_fma_f32 v[30:31], v[48:49], v[48:49], v[30:31]
v_pk_add_f32 v[28:29], v[28:29], v[50:51]
v_pk_fma_f32 v[30:31], v[50:51], v[50:51], v[30:31]
s_waitcnt lgkmcnt(0)
s_barrier
s_setprio 1
buffer_load_dwordx4 v[96:99], v17, s[16:19], 0 offen offset:256 sc0 sc1 nt
buffer_load_dwordx4 v[104:107], v17, s[16:19], 0 offen offset:384 sc0 sc1 nt
s_waitcnt vmcnt(2)
v_lshlrev_b32 v36, 16, v160
v_and_b32 v37, s50, v160
v_lshlrev_b32 v38, 16, v161
v_and_b32 v39, s50, v161
v_lshlrev_b32 v40, 16, v162
v_and_b32 v41, s50, v162
v_lshlrev_b32 v42, 16, v163
v_and_b32 v43, s50, v163
s_waitcnt vmcnt(3)
v_lshlrev_b32 v44, 16, v88
v_and_b32 v45, s50, v88
v_lshlrev_b32 v46, 16, v89
v_and_b32 v47, s50, v89
v_lshlrev_b32 v48, 16, v90
v_and_b32 v49, s50, v90
v_lshlrev_b32 v50, 16, v91
v_and_b32 v51, s50, v91
v_sub_f32 v44, v44, v166
v_sub_f32 v45, v45, v166
v_sub_f32 v46, v46, v166
v_sub_f32 v47, v47, v166
v_sub_f32 v48, v48, v166
v_sub_f32 v49, v49, v166
v_sub_f32 v50, v50, v166
v_sub_f32 v51, v51, v166
v_mul_f32 v68, v44, v36
v_mul_f32 v69, v45, v37
v_cvt_pk_bf16_f32 v72, v68, v69
v_mul_f32 v70, v46, v38
v_mul_f32 v71, v47, v39
v_cvt_pk_bf16_f32 v73, v70, v71
v_mul_f32 v68, v48, v40
v_mul_f32 v69, v49, v41
v_cvt_pk_bf16_f32 v74, v68, v69
v_mul_f32 v70, v50, v42
v_mul_f32 v71, v51, v43
v_cvt_pk_bf16_f32 v75, v70, v71
ds_write_b128 v19, v[72:75] offset:16384
ds_read_b128 v[36:39], v26 offset:512
ds_read_b128 v[40:43], v26 offset:528
s_setprio 0
v_pk_add_f32 v[28:29], v[28:29], v[44:45]
v_pk_fma_f32 v[30:31], v[44:45], v[44:45], v[30:31]
v_pk_add_f32 v[28:29], v[28:29], v[46:47]
v_pk_fma_f32 v[30:31], v[46:47], v[46:47], v[30:31]
v_pk_add_f32 v[28:29], v[28:29], v[48:49]
v_pk_fma_f32 v[30:31], v[48:49], v[48:49], v[30:31]
v_pk_add_f32 v[28:29], v[28:29], v[50:51]
v_pk_fma_f32 v[30:31], v[50:51], v[50:51], v[30:31]
s_waitcnt lgkmcnt(0)
s_barrier
s_setprio 1
s_waitcnt vmcnt(1)
v_lshlrev_b32 v44, 16, v96
v_and_b32 v45, s50, v96
v_lshlrev_b32 v46, 16, v97
v_and_b32 v47, s50, v97
v_lshlrev_b32 v48, 16, v98
v_and_b32 v49, s50, v98
v_lshlrev_b32 v50, 16, v99
v_and_b32 v51, s50, v99
v_sub_f32 v44, v44, v166
v_sub_f32 v45, v45, v166
v_sub_f32 v46, v46, v166
v_sub_f32 v47, v47, v166
v_sub_f32 v48, v48, v166
v_sub_f32 v49, v49, v166
v_sub_f32 v50, v50, v166
v_sub_f32 v51, v51, v166
buffer_load_dwordx4 v[112:115], v17, s[16:19], 0 offen offset:512 sc0 sc1 nt
v_mul_f32 v68, v44, v36
v_mul_f32 v69, v45, v37
v_cvt_pk_bf16_f32 v72, v68, v69
v_mul_f32 v70, v46, v38
v_mul_f32 v71, v47, v39
v_cvt_pk_bf16_f32 v73, v70, v71
v_mul_f32 v68, v48, v40
v_mul_f32 v69, v49, v41
v_cvt_pk_bf16_f32 v74, v68, v69
v_mul_f32 v70, v50, v42
v_mul_f32 v71, v51, v43
v_cvt_pk_bf16_f32 v75, v70, v71
ds_write_b128 v19, v[72:75] offset:0
ds_read_b128 v[36:39], v26 offset:768
ds_read_b128 v[40:43], v26 offset:784
s_setprio 0
v_pk_add_f32 v[28:29], v[28:29], v[44:45]
v_pk_fma_f32 v[30:31], v[44:45], v[44:45], v[30:31]
v_pk_add_f32 v[28:29], v[28:29], v[46:47]
v_pk_fma_f32 v[30:31], v[46:47], v[46:47], v[30:31]
v_pk_add_f32 v[28:29], v[28:29], v[48:49]
v_pk_fma_f32 v[30:31], v[48:49], v[48:49], v[30:31]
v_pk_add_f32 v[28:29], v[28:29], v[50:51]
v_pk_fma_f32 v[30:31], v[50:51], v[50:51], v[30:31]
s_waitcnt lgkmcnt(0)
s_barrier
s_setprio 1
s_waitcnt vmcnt(1)
v_lshlrev_b32 v44, 16, v104
v_and_b32 v45, s50, v104
v_lshlrev_b32 v46, 16, v105
v_and_b32 v47, s50, v105
v_lshlrev_b32 v48, 16, v106
v_and_b32 v49, s50, v106
v_lshlrev_b32 v50, 16, v107
v_and_b32 v51, s50, v107
v_sub_f32 v44, v44, v166
v_sub_f32 v45, v45, v166
v_sub_f32 v46, v46, v166
v_sub_f32 v47, v47, v166
v_sub_f32 v48, v48, v166
v_sub_f32 v49, v49, v166
v_sub_f32 v50, v50, v166
v_sub_f32 v51, v51, v166
buffer_load_dwordx4 v[120:123], v17, s[16:19], 0 offen offset:640 sc0 sc1 nt
v_mul_f32 v68, v44, v36
v_mul_f32 v69, v45, v37
v_cvt_pk_bf16_f32 v72, v68, v69
v_mul_f32 v70, v46, v38
v_mul_f32 v71, v47, v39
v_cvt_pk_bf16_f32 v73, v70, v71
v_mul_f32 v68, v48, v40
v_mul_f32 v69, v49, v41
v_cvt_pk_bf16_f32 v74, v68, v69
v_mul_f32 v70, v50, v42
v_mul_f32 v71, v51, v43
v_cvt_pk_bf16_f32 v75, v70, v71
ds_write_b128 v19, v[72:75] offset:16384
ds_read_b128 v[36:39], v26 offset:1024
ds_read_b128 v[40:43], v26 offset:1040
s_setprio 0
v_pk_add_f32 v[28:29], v[28:29], v[44:45]
v_pk_fma_f32 v[30:31], v[44:45], v[44:45], v[30:31]
v_pk_add_f32 v[28:29], v[28:29], v[46:47]
v_pk_fma_f32 v[30:31], v[46:47], v[46:47], v[30:31]
v_pk_add_f32 v[28:29], v[28:29], v[48:49]
v_pk_fma_f32 v[30:31], v[48:49], v[48:49], v[30:31]
v_pk_add_f32 v[28:29], v[28:29], v[50:51]
v_pk_fma_f32 v[30:31], v[50:51], v[50:51], v[30:31]
s_waitcnt lgkmcnt(0)
s_barrier
s_setprio 1
s_waitcnt vmcnt(1)
v_lshlrev_b32 v44, 16, v112
v_and_b32 v45, s50, v112
v_lshlrev_b32 v46, 16, v113
v_and_b32 v47, s50, v113
v_lshlrev_b32 v48, 16, v114
v_and_b32 v49, s50, v114
v_lshlrev_b32 v50, 16, v115
v_and_b32 v51, s50, v115
v_sub_f32 v44, v44, v166
v_sub_f32 v45, v45, v166
v_sub_f32 v46, v46, v166
v_sub_f32 v47, v47, v166
v_sub_f32 v48, v48, v166
v_sub_f32 v49, v49, v166
v_sub_f32 v50, v50, v166
v_sub_f32 v51, v51, v166
buffer_load_dwordx4 v[128:131], v17, s[16:19], 0 offen offset:768 sc0 sc1 nt
v_mul_f32 v68, v44, v36
v_mul_f32 v69, v45, v37
v_cvt_pk_bf16_f32 v72, v68, v69
v_mul_f32 v70, v46, v38
v_mul_f32 v71, v47, v39
v_cvt_pk_bf16_f32 v73, v70, v71
v_mul_f32 v68, v48, v40
v_mul_f32 v69, v49, v41
v_cvt_pk_bf16_f32 v74, v68, v69
v_mul_f32 v70, v50, v42
v_mul_f32 v71, v51, v43
v_cvt_pk_bf16_f32 v75, v70, v71
ds_write_b128 v19, v[72:75] offset:0
ds_read_b128 v[36:39], v26 offset:1280
ds_read_b128 v[40:43], v26 offset:1296
s_setprio 0
v_pk_add_f32 v[28:29], v[28:29], v[44:45]
v_pk_fma_f32 v[30:31], v[44:45], v[44:45], v[30:31]
v_pk_add_f32 v[28:29], v[28:29], v[46:47]
v_pk_fma_f32 v[30:31], v[46:47], v[46:47], v[30:31]
v_pk_add_f32 v[28:29], v[28:29], v[48:49]
v_pk_fma_f32 v[30:31], v[48:49], v[48:49], v[30:31]
v_pk_add_f32 v[28:29], v[28:29], v[50:51]
v_pk_fma_f32 v[30:31], v[50:51], v[50:51], v[30:31]
s_waitcnt lgkmcnt(0)
s_barrier
s_setprio 1
s_waitcnt vmcnt(1)
v_lshlrev_b32 v44, 16, v120
v_and_b32 v45, s50, v120
v_lshlrev_b32 v46, 16, v121
v_and_b32 v47, s50, v121
v_lshlrev_b32 v48, 16, v122
v_and_b32 v49, s50, v122
v_lshlrev_b32 v50, 16, v123
v_and_b32 v51, s50, v123
v_sub_f32 v44, v44, v166
v_sub_f32 v45, v45, v166
v_sub_f32 v46, v46, v166
v_sub_f32 v47, v47, v166
v_sub_f32 v48, v48, v166
v_sub_f32 v49, v49, v166
v_sub_f32 v50, v50, v166
v_sub_f32 v51, v51, v166
buffer_load_dwordx4 v[136:139], v17, s[16:19], 0 offen offset:896 sc0 sc1 nt
v_mul_f32 v68, v44, v36
v_mul_f32 v69, v45, v37
v_cvt_pk_bf16_f32 v72, v68, v69
v_mul_f32 v70, v46, v38
v_mul_f32 v71, v47, v39
v_cvt_pk_bf16_f32 v73, v70, v71
v_mul_f32 v68, v48, v40
v_mul_f32 v69, v49, v41
v_cvt_pk_bf16_f32 v74, v68, v69
v_mul_f32 v70, v50, v42
v_mul_f32 v71, v51, v43
v_cvt_pk_bf16_f32 v75, v70, v71
ds_write_b128 v19, v[72:75] offset:16384
ds_read_b128 v[36:39], v26 offset:1536
ds_read_b128 v[40:43], v26 offset:1552
s_setprio 0
v_pk_add_f32 v[28:29], v[28:29], v[44:45]
v_pk_fma_f32 v[30:31], v[44:45], v[44:45], v[30:31]
v_pk_add_f32 v[28:29], v[28:29], v[46:47]
v_pk_fma_f32 v[30:31], v[46:47], v[46:47], v[30:31]
v_pk_add_f32 v[28:29], v[28:29], v[48:49]
v_pk_fma_f32 v[30:31], v[48:49], v[48:49], v[30:31]
v_pk_add_f32 v[28:29], v[28:29], v[50:51]
v_pk_fma_f32 v[30:31], v[50:51], v[50:51], v[30:31]
s_waitcnt lgkmcnt(0)
s_barrier
s_setprio 1
s_waitcnt vmcnt(1)
v_lshlrev_b32 v44, 16, v128
v_and_b32 v45, s50, v128
v_lshlrev_b32 v46, 16, v129
v_and_b32 v47, s50, v129
v_lshlrev_b32 v48, 16, v130
v_and_b32 v49, s50, v130
v_lshlrev_b32 v50, 16, v131
v_and_b32 v51, s50, v131
v_sub_f32 v44, v44, v166
v_sub_f32 v45, v45, v166
v_sub_f32 v46, v46, v166
v_sub_f32 v47, v47, v166
v_sub_f32 v48, v48, v166
v_sub_f32 v49, v49, v166
v_sub_f32 v50, v50, v166
v_sub_f32 v51, v51, v166
buffer_load_dwordx4 v[144:147], v17, s[16:19], 0 offen offset:1024 sc0 sc1 nt
v_mul_f32 v68, v44, v36
v_mul_f32 v69, v45, v37
v_cvt_pk_bf16_f32 v72, v68, v69
v_mul_f32 v70, v46, v38
v_mul_f32 v71, v47, v39
v_cvt_pk_bf16_f32 v73, v70, v71
v_mul_f32 v68, v48, v40
v_mul_f32 v69, v49, v41
v_cvt_pk_bf16_f32 v74, v68, v69
v_mul_f32 v70, v50, v42
v_mul_f32 v71, v51, v43
v_cvt_pk_bf16_f32 v75, v70, v71
ds_write_b128 v19, v[72:75] offset:0
ds_read_b128 v[36:39], v26 offset:1792
ds_read_b128 v[40:43], v26 offset:1808
s_setprio 0
v_pk_add_f32 v[28:29], v[28:29], v[44:45]
v_pk_fma_f32 v[30:31], v[44:45], v[44:45], v[30:31]
v_pk_add_f32 v[28:29], v[28:29], v[46:47]
v_pk_fma_f32 v[30:31], v[46:47], v[46:47], v[30:31]
v_pk_add_f32 v[28:29], v[28:29], v[48:49]
v_pk_fma_f32 v[30:31], v[48:49], v[48:49], v[30:31]
v_pk_add_f32 v[28:29], v[28:29], v[50:51]
v_pk_fma_f32 v[30:31], v[50:51], v[50:51], v[30:31]
s_waitcnt lgkmcnt(0)
s_barrier
s_setprio 1
s_waitcnt vmcnt(1)
v_lshlrev_b32 v44, 16, v136
v_and_b32 v45, s50, v136
v_lshlrev_b32 v46, 16, v137
v_and_b32 v47, s50, v137
v_lshlrev_b32 v48, 16, v138
v_and_b32 v49, s50, v138
v_lshlrev_b32 v50, 16, v139
v_and_b32 v51, s50, v139
v_sub_f32 v44, v44, v166
v_sub_f32 v45, v45, v166
v_sub_f32 v46, v46, v166
v_sub_f32 v47, v47, v166
v_sub_f32 v48, v48, v166
v_sub_f32 v49, v49, v166
v_sub_f32 v50, v50, v166
v_sub_f32 v51, v51, v166
v_mul_f32 v68, v44, v36
v_mul_f32 v69, v45, v37
v_cvt_pk_bf16_f32 v72, v68, v69
v_mul_f32 v70, v46, v38
v_mul_f32 v71, v47, v39
v_cvt_pk_bf16_f32 v73, v70, v71
v_mul_f32 v68, v48, v40
v_mul_f32 v69, v49, v41
v_cvt_pk_bf16_f32 v74, v68, v69
v_mul_f32 v70, v50, v42
v_mul_f32 v71, v51, v43
v_cvt_pk_bf16_f32 v75, v70, v71
ds_write_b128 v19, v[72:75] offset:16384
ds_read_b128 v[36:39], v26 offset:2048
ds_read_b128 v[40:43], v26 offset:2064
s_setprio 0
v_pk_add_f32 v[28:29], v[28:29], v[44:45]
v_pk_fma_f32 v[30:31], v[44:45], v[44:45], v[30:31]
v_pk_add_f32 v[28:29], v[28:29], v[46:47]
v_pk_fma_f32 v[30:31], v[46:47], v[46:47], v[30:31]
v_pk_add_f32 v[28:29], v[28:29], v[48:49]
v_pk_fma_f32 v[30:31], v[48:49], v[48:49], v[30:31]
v_pk_add_f32 v[28:29], v[28:29], v[50:51]
v_pk_fma_f32 v[30:31], v[50:51], v[50:51], v[30:31]
s_waitcnt lgkmcnt(0)
s_barrier
s_setprio 1
s_waitcnt vmcnt(0)
v_lshlrev_b32 v44, 16, v144
v_and_b32 v45, s50, v144
v_lshlrev_b32 v46, 16, v145
v_and_b32 v47, s50, v145
v_lshlrev_b32 v48, 16, v146
v_and_b32 v49, s50, v146
v_lshlrev_b32 v50, 16, v147
v_and_b32 v51, s50, v147
v_sub_f32 v44, v44, v166
v_sub_f32 v45, v45, v166
v_sub_f32 v46, v46, v166
v_sub_f32 v47, v47, v166
v_sub_f32 v48, v48, v166
v_sub_f32 v49, v49, v166
v_sub_f32 v50, v50, v166
v_sub_f32 v51, v51, v166
v_mul_f32 v68, v44, v36
v_mul_f32 v69, v45, v37
v_cvt_pk_bf16_f32 v72, v68, v69
v_mul_f32 v70, v46, v38
v_mul_f32 v71, v47, v39
v_cvt_pk_bf16_f32 v73, v70, v71
v_mul_f32 v68, v48, v40
v_mul_f32 v69, v49, v41
v_cvt_pk_bf16_f32 v74, v68, v69
v_mul_f32 v70, v50, v42
v_mul_f32 v71, v51, v43
v_cvt_pk_bf16_f32 v75, v70, v71
ds_write_b128 v19, v[72:75] offset:0
v_pk_add_f32 v[28:29], v[28:29], v[44:45]
v_pk_fma_f32 v[30:31], v[44:45], v[44:45], v[30:31]
v_pk_add_f32 v[28:29], v[28:29], v[46:47]
v_pk_fma_f32 v[30:31], v[46:47], v[46:47], v[30:31]
v_pk_add_f32 v[28:29], v[28:29], v[48:49]
v_pk_fma_f32 v[30:31], v[48:49], v[48:49], v[30:31]
v_pk_add_f32 v[28:29], v[28:29], v[50:51]
v_pk_fma_f32 v[30:31], v[50:51], v[50:51], v[30:31]
s_waitcnt vmcnt(0)
s_waitcnt lgkmcnt(0)
s_barrier
s_setprio 3
s_branch L_pstats
L_p2:
s_setprio 2
s_waitcnt lgkmcnt(0)
s_mov_b32 s16, s4
s_mov_b32 s17, s5
s_mov_b32 s18, 9437184
s_mov_b32 s19, 0x20000
s_mov_b32 s24, s6
s_mov_b32 s25, s7
s_mov_b32 s26, 1152
s_mov_b32 s27, 0x20000
s_movk_i32 s58, 9216
buffer_load_dwordx4 v[156:159], v5, s[24:27], 0 offen
buffer_load_dwordx4 v[80:83], v17, s[16:19], 0 offen offset:0 sc0 sc1 nt
buffer_load_dwordx4 v[84:87], v17, s[16:19], s58 offen offset:0 sc0 sc1 nt
v_lshlrev_b32 v26, 5, v2
v_add_u32 v26, 122880, v26
s_lshl_b32 s48, s47, 10
s_add_u32 s48, s48, 131072
v_lshlrev_b32 v4, 4, v1
v_add_u32 v19, s48, v4
v_mov_b32 v28, 0
v_mov_b32 v29, 0
v_mov_b32 v30, 0
v_mov_b32 v31, 0
v_mov_b32 v32, 0
v_mov_b32 v33, 0
v_mov_b32 v34, 0
v_mov_b32 v35, 0
buffer_load_dwordx4 v[88:91], v17, s[16:19], 0 offen offset:128 sc0 sc1 nt
buffer_load_dwordx4 v[92:95], v17, s[16:19], s58 offen offset:128 sc0 sc1 nt
buffer_load_dwordx4 v[160:163], v5, s[24:27], 0 offen offset:128
s_mul_i32 s48, s37, 110592
s_mul_i32 s49, s38, 384
s_add_u32 s48, s48, s49
s_mul_i32 s52, s36, 9216
s_add_u32 s48, s48, s52
s_mul_i32 s52, s36, 3264
v_add_u32 v6, 0, v1
v_mul_u32_u24 v7, 2731, v6
v_lshrrev_b32 v7, 16, v7
v_mul_u32_u24 v8, 24, v7
v_sub_u32 v6, v6, v8
v_lshlrev_b32 v6, 4, v6
v_mul_u32_u24 v8, 408, v7
v_add3_u32 v20, v8, v6, s52
v_mul_u32_u24 v8, 1152, v7
v_add3_u32 v23, v8, v6, s48
v_add_u32 v6, 64, v1
v_mul_u32_u24 v7, 2731, v6
v_lshrrev_b32 v7, 16, v7
v_mul_u32_u24 v8, 24, v7
v_sub_u32 v6, v6, v8
v_lshlrev_b32 v6, 4, v6
v_mul_u32_u24 v8, 408, v7
v_add3_u32 v21, v8, v6, s52
v_mul_u32_u24 v8, 1152, v7
v_add3_u32 v24, v8, v6, s48
v_add_u32 v6, 128, v1
v_mul_u32_u24 v7, 2731, v6
v_lshrrev_b32 v7, 16, v7
v_mul_u32_u24 v8, 24, v7
v_sub_u32 v6, v6, v8
v_lshlrev_b32 v6, 4, v6
v_mul_u32_u24 v8, 408, v7
v_add3_u32 v22, v8, v6, s52
v_mul_u32_u24 v8, 1152, v7
v_add3_u32 v25, v8, v6, s48
v_lshlrev_b32 v6, 4, v1
v_add_u32 v164, 39168, v6
s_add_u32 s51, s37, 8160
s_mul_i32 s51, s51, 1152
s_add_u32 s51, s51, s49
v_add_u32 v6, s51, v6
v_mov_b32 v7, 0x40000000
v_cmp_gt_u32 vcc, 24, v1
s_nop 1
v_cndmask_b32 v165, v7, v6, vcc
s_setprio 2
s_waitcnt vmcnt(3)
v_lshlrev_b32 v36, 16, v156
v_and_b32 v37, s50, v156
v_lshlrev_b32 v38, 16, v157
v_and_b32 v39, s50, v157
v_lshlrev_b32 v40, 16, v158
v_and_b32 v41, s50, v158
v_lshlrev_b32 v42, 16, v159
v_and_b32 v43, s50, v159
v_lshlrev_b32 v44, 16, v80
v_and_b32 v45, s50, v80
v_lshlrev_b32 v46, 16, v81
v_and_b32 v47, s50, v81
v_lshlrev_b32 v48, 16, v82
v_and_b32 v49, s50, v82
v_lshlrev_b32 v50, 16, v83
v_and_b32 v51, s50, v83
v_lshlrev_b32 v52, 16, v84
v_and_b32 v53, s50, v84
v_lshlrev_b32 v54, 16, v85
v_and_b32 v55, s50, v85
v_lshlrev_b32 v56, 16, v86
v_and_b32 v57, s50, v86
v_lshlrev_b32 v58, 16, v87
v_and_b32 v59, s50, v87
v_add_f32 v166, v44, v45
v_add_f32 v68, v46, v47
v_add_f32 v166, v166, v48
v_add_f32 v68, v68, v49
v_add_f32 v166, v166, v50
v_add_f32 v68, v68, v51
v_add_f32 v166, v166, v68
v_add_f32 v167, v52, v53
v_add_f32 v69, v54, v55
v_add_f32 v167, v167, v56
v_add_f32 v69, v69, v57
v_add_f32 v167, v167, v58
v_add_f32 v69, v69, v59
v_add_f32 v167, v167, v69
s_nop 1
v_add_f32_dpp v166, v166, v166 quad_perm:[1,0,3,2] row_mask:0xf bank_mask:0xf
v_add_f32_dpp v167, v167, v167 quad_perm:[1,0,3,2] row_mask:0xf bank_mask:0xf
s_nop 1
v_add_f32_dpp v166, v166, v166 quad_perm:[2,3,0,1] row_mask:0xf bank_mask:0xf
v_add_f32_dpp v167, v167, v167 quad_perm:[2,3,0,1] row_mask:0xf bank_mask:0xf
v_mov_b32 v68, v166
v_mov_b32 v69, v167
s_nop 1
v_permlane32_swap_b32 v166, v68
v_permlane32_swap_b32 v167, v69
s_nop 1
v_add_f32 v166, v166, v68
v_add_f32 v167, v167, v69
v_mul_f32 v166, 0x3c800000, v166
v_mul_f32 v167, 0x3c800000, v167
v_cvt_pk_bf16_f32 v166, v166, v166
v_cvt_pk_bf16_f32 v167, v167, v167
v_and_b32 v166, s50, v166
v_and_b32 v167, s50, v167
v_pk_add_f32 v[44:45], v[44:45], v[166:167] op_sel:[0,0] op_sel_hi:[1,0] neg_lo:[0,1] neg_hi:[0,1]
v_pk_add_f32 v[46:47], v[46:47], v[166:167] op_sel:[0,0] op_sel_hi:[1,0] neg_lo:[0,1] neg_hi:[0,1]
v_pk_add_f32 v[48:49], v[48:49], v[166:167] op_sel:[0,0] op_sel_hi:[1,0] neg_lo:[0,1] neg_hi:[0,1]
v_pk_add_f32 v[50:51], v[50:51], v[166:167] op_sel:[0,0] op_sel_hi:[1,0] neg_lo:[0,1] neg_hi:[0,1]
v_pk_mul_f32 v[144:145], v[44:45], v[36:37]
v_pk_mul_f32 v[146:147], v[46:47], v[38:39]
v_pk_mul_f32 v[148:149], v[48:49], v[40:41]
v_pk_mul_f32 v[150:151], v[50:51], v[42:43]
v_cvt_pk_bf16_f32 v72, v144, v145
v_cvt_pk_bf16_f32 v73, v146, v147
v_cvt_pk_bf16_f32 v74, v148, v149
v_cvt_pk_bf16_f32 v75, v150, v151
ds_write_b128 v19, v[72:75] offset:0
v_pk_add_f32 v[52:53], v[52:53], v[166:167] op_sel:[0,1] op_sel_hi:[1,1] neg_lo:[0,1] neg_hi:[0,1]
v_pk_add_f32 v[54:55], v[54:55], v[166:167] op_sel:[0,1] op_sel_hi:[1,1] neg_lo:[0,1] neg_hi:[0,1]
v_pk_add_f32 v[56:57], v[56:57], v[166:167] op_sel:[0,1] op_sel_hi:[1,1] neg_lo:[0,1] neg_hi:[0,1]
v_pk_add_f32 v[58:59], v[58:59], v[166:167] op_sel:[0,1] op_sel_hi:[1,1] neg_lo:[0,1] neg_hi:[0,1]
v_pk_mul_f32 v[144:145], v[52:53], v[36:37]
v_pk_mul_f32 v[146:147], v[54:55], v[38:39]
v_pk_mul_f32 v[148:149], v[56:57], v[40:41]
v_pk_mul_f32 v[150:151], v[58:59], v[42:43]
v_cvt_pk_bf16_f32 v76, v144, v145
v_cvt_pk_bf16_f32 v77, v146, v147
v_cvt_pk_bf16_f32 v78, v148, v149
v_cvt_pk_bf16_f32 v79, v150, v151
ds_write_b128 v19, v[76:79] offset:1024
v_pk_add_f32 v[28:29], v[28:29], v[44:45]
v_pk_fma_f32 v[30:31], v[44:45], v[44:45], v[30:31]
v_pk_add_f32 v[28:29], v[28:29], v[46:47]
v_pk_fma_f32 v[30:31], v[46:47], v[46:47], v[30:31]
v_pk_add_f32 v[28:29], v[28:29], v[48:49]
v_pk_fma_f32 v[30:31], v[48:49], v[48:49], v[30:31]
v_pk_add_f32 v[28:29], v[28:29], v[50:51]
v_pk_fma_f32 v[30:31], v[50:51], v[50:51], v[30:31]
v_pk_add_f32 v[32:33], v[32:33], v[52:53]
v_pk_fma_f32 v[34:35], v[52:53], v[52:53], v[34:35]
v_pk_add_f32 v[32:33], v[32:33], v[54:55]
v_pk_fma_f32 v[34:35], v[54:55], v[54:55], v[34:35]
v_pk_add_f32 v[32:33], v[32:33], v[56:57]
v_pk_fma_f32 v[34:35], v[56:57], v[56:57], v[34:35]
v_pk_add_f32 v[32:33], v[32:33], v[58:59]
v_pk_fma_f32 v[34:35], v[58:59], v[58:59], v[34:35]
s_waitcnt lgkmcnt(0)
s_barrier
s_setprio 2
buffer_load_dwordx4 v[96:99], v17, s[16:19], 0 offen offset:256 sc0 sc1 nt
buffer_load_dwordx4 v[100:103], v17, s[16:19], s58 offen offset:256 sc0 sc1 nt
buffer_load_dwordx4 v[104:107], v17, s[16:19], 0 offen offset:384 sc0 sc1 nt
buffer_load_dwordx4 v[108:111], v17, s[16:19], s58 offen offset:384 sc0 sc1 nt
s_waitcnt vmcnt(4)
v_lshlrev_b32 v36, 16, v160
v_and_b32 v37, s50, v160
v_lshlrev_b32 v38, 16, v161
v_and_b32 v39, s50, v161
v_lshlrev_b32 v40, 16, v162
v_and_b32 v41, s50, v162
v_lshlrev_b32 v42, 16, v163
v_and_b32 v43, s50, v163
s_waitcnt vmcnt(5)
v_lshlrev_b32 v44, 16, v88
v_and_b32 v45, s50, v88
v_lshlrev_b32 v46, 16, v89
v_and_b32 v47, s50, v89
v_lshlrev_b32 v48, 16, v90
v_and_b32 v49, s50, v90
v_lshlrev_b32 v50, 16, v91
v_and_b32 v51, s50, v91
v_lshlrev_b32 v52, 16, v92
v_and_b32 v53, s50, v92
v_lshlrev_b32 v54, 16, v93
v_and_b32 v55, s50, v93
v_lshlrev_b32 v56, 16, v94
v_and_b32 v57, s50, v94
v_lshlrev_b32 v58, 16, v95
v_and_b32 v59, s50, v95
v_sub_f32 v44, v44, v166
v_sub_f32 v45, v45, v166
v_sub_f32 v46, v46, v166
v_sub_f32 v47, v47, v166
v_sub_f32 v48, v48, v166
v_sub_f32 v49, v49, v166
v_sub_f32 v50, v50, v166
v_sub_f32 v51, v51, v166
v_sub_f32 v52, v52, v167
v_sub_f32 v53, v53, v167
v_sub_f32 v54, v54, v167
v_sub_f32 v55, v55, v167
v_sub_f32 v56, v56, v167
v_sub_f32 v57, v57, v167
v_sub_f32 v58, v58, v167
v_sub_f32 v59, v59, v167
v_mul_f32 v68, v44, v36
v_mul_f32 v69, v45, v37
v_cvt_pk_bf16_f32 v72, v68, v69
v_mul_f32 v70, v46, v38
v_mul_f32 v71, v47, v39
v_cvt_pk_bf16_f32 v73, v70, v71
v_mul_f32 v68, v48, v40
v_mul_f32 v69, v49, v41
v_cvt_pk_bf16_f32 v74, v68, v69
v_mul_f32 v70, v50, v42
v_mul_f32 v71, v51, v43
v_cvt_pk_bf16_f32 v75, v70, v71
ds_write_b128 v19, v[72:75] offset:16384
v_mul_f32 v68, v52, v36
v_mul_f32 v69, v53, v37
v_cvt_pk_bf16_f32 v76, v68, v69
v_mul_f32 v70, v54, v38
v_mul_f32 v71, v55, v39
v_cvt_pk_bf16_f32 v77, v70, v71
v_mul_f32 v68, v56, v40
v_mul_f32 v69, v57, v41
v_cvt_pk_bf16_f32 v78, v68, v69
v_mul_f32 v70, v58, v42
v_mul_f32 v71, v59, v43
v_cvt_pk_bf16_f32 v79, v70, v71
ds_write_b128 v19, v[76:79] offset:17408
ds_read_b128 v[36:39], v26 offset:512
ds_read_b128 v[40:43], v26 offset:528
s_setprio 0
v_pk_add_f32 v[28:29], v[28:29], v[44:45]
v_pk_fma_f32 v[30:31], v[44:45], v[44:45], v[30:31]
v_pk_add_f32 v[32:33], v[32:33], v[52:53]
v_pk_fma_f32 v[34:35], v[52:53], v[52:53], v[34:35]
v_pk_add_f32 v[28:29], v[28:29], v[46:47]
v_pk_fma_f32 v[30:31], v[46:47], v[46:47], v[30:31]
v_pk_add_f32 v[32:33], v[32:33], v[54:55]
v_pk_fma_f32 v[34:35], v[54:55], v[54:55], v[34:35]
v_pk_add_f32 v[28:29], v[28:29], v[48:49]
v_pk_fma_f32 v[30:31], v[48:49], v[48:49], v[30:31]
v_pk_add_f32 v[32:33], v[32:33], v[56:57]
v_pk_fma_f32 v[34:35], v[56:57], v[56:57], v[34:35]
v_pk_add_f32 v[28:29], v[28:29], v[50:51]
v_pk_fma_f32 v[30:31], v[50:51], v[50:51], v[30:31]
v_pk_add_f32 v[32:33], v[32:33], v[58:59]
v_pk_fma_f32 v[34:35], v[58:59], v[58:59], v[34:35]
s_waitcnt lgkmcnt(0)
s_barrier
s_setprio 2
s_waitcnt vmcnt(2)
v_lshlrev_b32 v44, 16, v96
v_and_b32 v45, s50, v96
v_lshlrev_b32 v46, 16, v97
v_and_b32 v47, s50, v97
v_lshlrev_b32 v48, 16, v98
v_and_b32 v49, s50, v98
v_lshlrev_b32 v50, 16, v99
v_and_b32 v51, s50, v99
v_lshlrev_b32 v52, 16, v100
v_and_b32 v53, s50, v100
v_lshlrev_b32 v54, 16, v101
v_and_b32 v55, s50, v101
v_lshlrev_b32 v56, 16, v102
v_and_b32 v57, s50, v102
v_lshlrev_b32 v58, 16, v103
v_and_b32 v59, s50, v103
v_sub_f32 v44, v44, v166
v_sub_f32 v45, v45, v166
v_sub_f32 v46, v46, v166
v_sub_f32 v47, v47, v166
v_sub_f32 v48, v48, v166
v_sub_f32 v49, v49, v166
v_sub_f32 v50, v50, v166
v_sub_f32 v51, v51, v166
v_sub_f32 v52, v52, v167
v_sub_f32 v53, v53, v167
v_sub_f32 v54, v54, v167
v_sub_f32 v55, v55, v167
v_sub_f32 v56, v56, v167
v_sub_f32 v57, v57, v167
v_sub_f32 v58, v58, v167
v_sub_f32 v59, v59, v167
buffer_load_dwordx4 v[112:115], v17, s[16:19], 0 offen offset:512 sc0 sc1 nt
buffer_load_dwordx4 v[116:119], v17, s[16:19], s58 offen offset:512 sc0 sc1 nt
v_mul_f32 v68, v44, v36
v_mul_f32 v69, v45, v37
v_cvt_pk_bf16_f32 v72, v68, v69
v_mul_f32 v70, v46, v38
v_mul_f32 v71, v47, v39
v_cvt_pk_bf16_f32 v73, v70, v71
v_mul_f32 v68, v48, v40
v_mul_f32 v69, v49, v41
v_cvt_pk_bf16_f32 v74, v68, v69
v_mul_f32 v70, v50, v42
v_mul_f32 v71, v51, v43
v_cvt_pk_bf16_f32 v75, v70, v71
ds_write_b128 v19, v[72:75] offset:0
v_mul_f32 v68, v52, v36
v_mul_f32 v69, v53, v37
v_cvt_pk_bf16_f32 v76, v68, v69
v_mul_f32 v70, v54, v38
v_mul_f32 v71, v55, v39
v_cvt_pk_bf16_f32 v77, v70, v71
v_mul_f32 v68, v56, v40
v_mul_f32 v69, v57, v41
v_cvt_pk_bf16_f32 v78, v68, v69
v_mul_f32 v70, v58, v42
v_mul_f32 v71, v59, v43
v_cvt_pk_bf16_f32 v79, v70, v71
ds_write_b128 v19, v[76:79] offset:1024
ds_read_b128 v[36:39], v26 offset:768
ds_read_b128 v[40:43], v26 offset:784
s_setprio 0
v_pk_add_f32 v[28:29], v[28:29], v[44:45]
v_pk_fma_f32 v[30:31], v[44:45], v[44:45], v[30:31]
v_pk_add_f32 v[32:33], v[32:33], v[52:53]
v_pk_fma_f32 v[34:35], v[52:53], v[52:53], v[34:35]
v_pk_add_f32 v[28:29], v[28:29], v[46:47]
v_pk_fma_f32 v[30:31], v[46:47], v[46:47], v[30:31]
v_pk_add_f32 v[32:33], v[32:33], v[54:55]
v_pk_fma_f32 v[34:35], v[54:55], v[54:55], v[34:35]
v_pk_add_f32 v[28:29], v[28:29], v[48:49]
v_pk_fma_f32 v[30:31], v[48:49], v[48:49], v[30:31]
v_pk_add_f32 v[32:33], v[32:33], v[56:57]
v_pk_fma_f32 v[34:35], v[56:57], v[56:57], v[34:35]
v_pk_add_f32 v[28:29], v[28:29], v[50:51]
v_pk_fma_f32 v[30:31], v[50:51], v[50:51], v[30:31]
v_pk_add_f32 v[32:33], v[32:33], v[58:59]
v_pk_fma_f32 v[34:35], v[58:59], v[58:59], v[34:35]
s_waitcnt lgkmcnt(0)
s_barrier
s_setprio 2
s_waitcnt vmcnt(2)
v_lshlrev_b32 v44, 16, v104
v_and_b32 v45, s50, v104
v_lshlrev_b32 v46, 16, v105
v_and_b32 v47, s50, v105
v_lshlrev_b32 v48, 16, v106
v_and_b32 v49, s50, v106
v_lshlrev_b32 v50, 16, v107
v_and_b32 v51, s50, v107
v_lshlrev_b32 v52, 16, v108
v_and_b32 v53, s50, v108
v_lshlrev_b32 v54, 16, v109
v_and_b32 v55, s50, v109
v_lshlrev_b32 v56, 16, v110
v_and_b32 v57, s50, v110
v_lshlrev_b32 v58, 16, v111
v_and_b32 v59, s50, v111
v_sub_f32 v44, v44, v166
v_sub_f32 v45, v45, v166
v_sub_f32 v46, v46, v166
v_sub_f32 v47, v47, v166
v_sub_f32 v48, v48, v166
v_sub_f32 v49, v49, v166
v_sub_f32 v50, v50, v166
v_sub_f32 v51, v51, v166
v_sub_f32 v52, v52, v167
v_sub_f32 v53, v53, v167
v_sub_f32 v54, v54, v167
v_sub_f32 v55, v55, v167
v_sub_f32 v56, v56, v167
v_sub_f32 v57, v57, v167
v_sub_f32 v58, v58, v167
v_sub_f32 v59, v59, v167
buffer_load_dwordx4 v[120:123], v17, s[16:19], 0 offen offset:640 sc0 sc1 nt
buffer_load_dwordx4 v[124:127], v17, s[16:19], s58 offen offset:640 sc0 sc1 nt
v_mul_f32 v68, v44, v36
v_mul_f32 v69, v45, v37
v_cvt_pk_bf16_f32 v72, v68, v69
v_mul_f32 v70, v46, v38
v_mul_f32 v71, v47, v39
v_cvt_pk_bf16_f32 v73, v70, v71
v_mul_f32 v68, v48, v40
v_mul_f32 v69, v49, v41
v_cvt_pk_bf16_f32 v74, v68, v69
v_mul_f32 v70, v50, v42
v_mul_f32 v71, v51, v43
v_cvt_pk_bf16_f32 v75, v70, v71
ds_write_b128 v19, v[72:75] offset:16384
v_mul_f32 v68, v52, v36
v_mul_f32 v69, v53, v37
v_cvt_pk_bf16_f32 v76, v68, v69
v_mul_f32 v70, v54, v38
v_mul_f32 v71, v55, v39
v_cvt_pk_bf16_f32 v77, v70, v71
v_mul_f32 v68, v56, v40
v_mul_f32 v69, v57, v41
v_cvt_pk_bf16_f32 v78, v68, v69
v_mul_f32 v70, v58, v42
v_mul_f32 v71, v59, v43
v_cvt_pk_bf16_f32 v79, v70, v71
ds_write_b128 v19, v[76:79] offset:17408
ds_read_b128 v[36:39], v26 offset:1024
ds_read_b128 v[40:43], v26 offset:1040
s_setprio 0
v_pk_add_f32 v[28:29], v[28:29], v[44:45]
v_pk_fma_f32 v[30:31], v[44:45], v[44:45], v[30:31]
v_pk_add_f32 v[32:33], v[32:33], v[52:53]
v_pk_fma_f32 v[34:35], v[52:53], v[52:53], v[34:35]
v_pk_add_f32 v[28:29], v[28:29], v[46:47]
v_pk_fma_f32 v[30:31], v[46:47], v[46:47], v[30:31]
v_pk_add_f32 v[32:33], v[32:33], v[54:55]
v_pk_fma_f32 v[34:35], v[54:55], v[54:55], v[34:35]
v_pk_add_f32 v[28:29], v[28:29], v[48:49]
v_pk_fma_f32 v[30:31], v[48:49], v[48:49], v[30:31]
v_pk_add_f32 v[32:33], v[32:33], v[56:57]
v_pk_fma_f32 v[34:35], v[56:57], v[56:57], v[34:35]
v_pk_add_f32 v[28:29], v[28:29], v[50:51]
v_pk_fma_f32 v[30:31], v[50:51], v[50:51], v[30:31]
v_pk_add_f32 v[32:33], v[32:33], v[58:59]
v_pk_fma_f32 v[34:35], v[58:59], v[58:59], v[34:35]
s_waitcnt lgkmcnt(0)
s_barrier
s_setprio 2
s_waitcnt vmcnt(2)
v_lshlrev_b32 v44, 16, v112
v_and_b32 v45, s50, v112
v_lshlrev_b32 v46, 16, v113
v_and_b32 v47, s50, v113
v_lshlrev_b32 v48, 16, v114
v_and_b32 v49, s50, v114
v_lshlrev_b32 v50, 16, v115
v_and_b32 v51, s50, v115
v_lshlrev_b32 v52, 16, v116
v_and_b32 v53, s50, v116
v_lshlrev_b32 v54, 16, v117
v_and_b32 v55, s50, v117
v_lshlrev_b32 v56, 16, v118
v_and_b32 v57, s50, v118
v_lshlrev_b32 v58, 16, v119
v_and_b32 v59, s50, v119
v_sub_f32 v44, v44, v166
v_sub_f32 v45, v45, v166
v_sub_f32 v46, v46, v166
v_sub_f32 v47, v47, v166
v_sub_f32 v48, v48, v166
v_sub_f32 v49, v49, v166
v_sub_f32 v50, v50, v166
v_sub_f32 v51, v51, v166
v_sub_f32 v52, v52, v167
v_sub_f32 v53, v53, v167
v_sub_f32 v54, v54, v167
v_sub_f32 v55, v55, v167
v_sub_f32 v56, v56, v167
v_sub_f32 v57, v57, v167
v_sub_f32 v58, v58, v167
v_sub_f32 v59, v59, v167
buffer_load_dwordx4 v[128:131], v17, s[16:19], 0 offen offset:768 sc0 sc1 nt
buffer_load_dwordx4 v[132:135], v17, s[16:19], s58 offen offset:768 sc0 sc1 nt
v_mul_f32 v68, v44, v36
v_mul_f32 v69, v45, v37
v_cvt_pk_bf16_f32 v72, v68, v69
v_mul_f32 v70, v46, v38
v_mul_f32 v71, v47, v39
v_cvt_pk_bf16_f32 v73, v70, v71
v_mul_f32 v68, v48, v40
v_mul_f32 v69, v49, v41
v_cvt_pk_bf16_f32 v74, v68, v69
v_mul_f32 v70, v50, v42
v_mul_f32 v71, v51, v43
v_cvt_pk_bf16_f32 v75, v70, v71
ds_write_b128 v19, v[72:75] offset:0
v_mul_f32 v68, v52, v36
v_mul_f32 v69, v53, v37
v_cvt_pk_bf16_f32 v76, v68, v69
v_mul_f32 v70, v54, v38
v_mul_f32 v71, v55, v39
v_cvt_pk_bf16_f32 v77, v70, v71
v_mul_f32 v68, v56, v40
v_mul_f32 v69, v57, v41
v_cvt_pk_bf16_f32 v78, v68, v69
v_mul_f32 v70, v58, v42
v_mul_f32 v71, v59, v43
v_cvt_pk_bf16_f32 v79, v70, v71
ds_write_b128 v19, v[76:79] offset:1024
ds_read_b128 v[36:39], v26 offset:1280
ds_read_b128 v[40:43], v26 offset:1296
s_setprio 0
v_pk_add_f32 v[28:29], v[28:29], v[44:45]
v_pk_fma_f32 v[30:31], v[44:45], v[44:45], v[30:31]
v_pk_add_f32 v[32:33], v[32:33], v[52:53]
v_pk_fma_f32 v[34:35], v[52:53], v[52:53], v[34:35]
v_pk_add_f32 v[28:29], v[28:29], v[46:47]
v_pk_fma_f32 v[30:31], v[46:47], v[46:47], v[30:31]
v_pk_add_f32 v[32:33], v[32:33], v[54:55]
v_pk_fma_f32 v[34:35], v[54:55], v[54:55], v[34:35]
v_pk_add_f32 v[28:29], v[28:29], v[48:49]
v_pk_fma_f32 v[30:31], v[48:49], v[48:49], v[30:31]
v_pk_add_f32 v[32:33], v[32:33], v[56:57]
v_pk_fma_f32 v[34:35], v[56:57], v[56:57], v[34:35]
v_pk_add_f32 v[28:29], v[28:29], v[50:51]
v_pk_fma_f32 v[30:31], v[50:51], v[50:51], v[30:31]
v_pk_add_f32 v[32:33], v[32:33], v[58:59]
v_pk_fma_f32 v[34:35], v[58:59], v[58:59], v[34:35]
s_waitcnt lgkmcnt(0)
s_barrier
s_setprio 2
s_waitcnt vmcnt(2)
v_lshlrev_b32 v44, 16, v120
v_and_b32 v45, s50, v120
v_lshlrev_b32 v46, 16, v121
v_and_b32 v47, s50, v121
v_lshlrev_b32 v48, 16, v122
v_and_b32 v49, s50, v122
v_lshlrev_b32 v50, 16, v123
v_and_b32 v51, s50, v123
v_lshlrev_b32 v52, 16, v124
v_and_b32 v53, s50, v124
v_lshlrev_b32 v54, 16, v125
v_and_b32 v55, s50, v125
v_lshlrev_b32 v56, 16, v126
v_and_b32 v57, s50, v126
v_lshlrev_b32 v58, 16, v127
v_and_b32 v59, s50, v127
v_sub_f32 v44, v44, v166
v_sub_f32 v45, v45, v166
v_sub_f32 v46, v46, v166
v_sub_f32 v47, v47, v166
v_sub_f32 v48, v48, v166
v_sub_f32 v49, v49, v166
v_sub_f32 v50, v50, v166
v_sub_f32 v51, v51, v166
v_sub_f32 v52, v52, v167
v_sub_f32 v53, v53, v167
v_sub_f32 v54, v54, v167
v_sub_f32 v55, v55, v167
v_sub_f32 v56, v56, v167
v_sub_f32 v57, v57, v167
v_sub_f32 v58, v58, v167
v_sub_f32 v59, v59, v167
buffer_load_dwordx4 v[136:139], v17, s[16:19], 0 offen offset:896 sc0 sc1 nt
buffer_load_dwordx4 v[140:143], v17, s[16:19], s58 offen offset:896 sc0 sc1 nt
v_mul_f32 v68, v44, v36
v_mul_f32 v69, v45, v37
v_cvt_pk_bf16_f32 v72, v68, v69
v_mul_f32 v70, v46, v38
v_mul_f32 v71, v47, v39
v_cvt_pk_bf16_f32 v73, v70, v71
v_mul_f32 v68, v48, v40
v_mul_f32 v69, v49, v41
v_cvt_pk_bf16_f32 v74, v68, v69
v_mul_f32 v70, v50, v42
v_mul_f32 v71, v51, v43
v_cvt_pk_bf16_f32 v75, v70, v71
ds_write_b128 v19, v[72:75] offset:16384
v_mul_f32 v68, v52, v36
v_mul_f32 v69, v53, v37
v_cvt_pk_bf16_f32 v76, v68, v69
v_mul_f32 v70, v54, v38
v_mul_f32 v71, v55, v39
v_cvt_pk_bf16_f32 v77, v70, v71
v_mul_f32 v68, v56, v40
v_mul_f32 v69, v57, v41
v_cvt_pk_bf16_f32 v78, v68, v69
v_mul_f32 v70, v58, v42
v_mul_f32 v71, v59, v43
v_cvt_pk_bf16_f32 v79, v70, v71
ds_write_b128 v19, v[76:79] offset:17408
ds_read_b128 v[36:39], v26 offset:1536
ds_read_b128 v[40:43], v26 offset:1552
s_setprio 0
v_pk_add_f32 v[28:29], v[28:29], v[44:45]
v_pk_fma_f32 v[30:31], v[44:45], v[44:45], v[30:31]
v_pk_add_f32 v[32:33], v[32:33], v[52:53]
v_pk_fma_f32 v[34:35], v[52:53], v[52:53], v[34:35]
v_pk_add_f32 v[28:29], v[28:29], v[46:47]
v_pk_fma_f32 v[30:31], v[46:47], v[46:47], v[30:31]
v_pk_add_f32 v[32:33], v[32:33], v[54:55]
v_pk_fma_f32 v[34:35], v[54:55], v[54:55], v[34:35]
v_pk_add_f32 v[28:29], v[28:29], v[48:49]
v_pk_fma_f32 v[30:31], v[48:49], v[48:49], v[30:31]
v_pk_add_f32 v[32:33], v[32:33], v[56:57]
v_pk_fma_f32 v[34:35], v[56:57], v[56:57], v[34:35]
v_pk_add_f32 v[28:29], v[28:29], v[50:51]
v_pk_fma_f32 v[30:31], v[50:51], v[50:51], v[30:31]
v_pk_add_f32 v[32:33], v[32:33], v[58:59]
v_pk_fma_f32 v[34:35], v[58:59], v[58:59], v[34:35]
s_waitcnt lgkmcnt(0)
s_barrier
s_setprio 2
s_waitcnt vmcnt(2)
v_lshlrev_b32 v44, 16, v128
v_and_b32 v45, s50, v128
v_lshlrev_b32 v46, 16, v129
v_and_b32 v47, s50, v129
v_lshlrev_b32 v48, 16, v130
v_and_b32 v49, s50, v130
v_lshlrev_b32 v50, 16, v131
v_and_b32 v51, s50, v131
v_lshlrev_b32 v52, 16, v132
v_and_b32 v53, s50, v132
v_lshlrev_b32 v54, 16, v133
v_and_b32 v55, s50, v133
v_lshlrev_b32 v56, 16, v134
v_and_b32 v57, s50, v134
v_lshlrev_b32 v58, 16, v135
v_and_b32 v59, s50, v135
v_sub_f32 v44, v44, v166
v_sub_f32 v45, v45, v166
v_sub_f32 v46, v46, v166
v_sub_f32 v47, v47, v166
v_sub_f32 v48, v48, v166
v_sub_f32 v49, v49, v166
v_sub_f32 v50, v50, v166
v_sub_f32 v51, v51, v166
v_sub_f32 v52, v52, v167
v_sub_f32 v53, v53, v167
v_sub_f32 v54, v54, v167
v_sub_f32 v55, v55, v167
v_sub_f32 v56, v56, v167
v_sub_f32 v57, v57, v167
v_sub_f32 v58, v58, v167
v_sub_f32 v59, v59, v167
buffer_load_dwordx4 v[144:147], v17, s[16:19], 0 offen offset:1024 sc0 sc1 nt
buffer_load_dwordx4 v[148:151], v17, s[16:19], s58 offen offset:1024 sc0 sc1 nt
v_mul_f32 v68, v44, v36
v_mul_f32 v69, v45, v37
v_cvt_pk_bf16_f32 v72, v68, v69
v_mul_f32 v70, v46, v38
v_mul_f32 v71, v47, v39
v_cvt_pk_bf16_f32 v73, v70, v71
v_mul_f32 v68, v48, v40
v_mul_f32 v69, v49, v41
v_cvt_pk_bf16_f32 v74, v68, v69
v_mul_f32 v70, v50, v42
v_mul_f32 v71, v51, v43
v_cvt_pk_bf16_f32 v75, v70, v71
ds_write_b128 v19, v[72:75] offset:0
v_mul_f32 v68, v52, v36
v_mul_f32 v69, v53, v37
v_cvt_pk_bf16_f32 v76, v68, v69
v_mul_f32 v70, v54, v38
v_mul_f32 v71, v55, v39
v_cvt_pk_bf16_f32 v77, v70, v71
v_mul_f32 v68, v56, v40
v_mul_f32 v69, v57, v41
v_cvt_pk_bf16_f32 v78, v68, v69
v_mul_f32 v70, v58, v42
v_mul_f32 v71, v59, v43
v_cvt_pk_bf16_f32 v79, v70, v71
ds_write_b128 v19, v[76:79] offset:1024
ds_read_b128 v[36:39], v26 offset:1792
ds_read_b128 v[40:43], v26 offset:1808
s_setprio 0
v_pk_add_f32 v[28:29], v[28:29], v[44:45]
v_pk_fma_f32 v[30:31], v[44:45], v[44:45], v[30:31]
v_pk_add_f32 v[32:33], v[32:33], v[52:53]
v_pk_fma_f32 v[34:35], v[52:53], v[52:53], v[34:35]
v_pk_add_f32 v[28:29], v[28:29], v[46:47]
v_pk_fma_f32 v[30:31], v[46:47], v[46:47], v[30:31]
v_pk_add_f32 v[32:33], v[32:33], v[54:55]
v_pk_fma_f32 v[34:35], v[54:55], v[54:55], v[34:35]
v_pk_add_f32 v[28:29], v[28:29], v[48:49]
v_pk_fma_f32 v[30:31], v[48:49], v[48:49], v[30:31]
v_pk_add_f32 v[32:33], v[32:33], v[56:57]
v_pk_fma_f32 v[34:35], v[56:57], v[56:57], v[34:35]
v_pk_add_f32 v[28:29], v[28:29], v[50:51]
v_pk_fma_f32 v[30:31], v[50:51], v[50:51], v[30:31]
v_pk_add_f32 v[32:33], v[32:33], v[58:59]
v_pk_fma_f32 v[34:35], v[58:59], v[58:59], v[34:35]
s_waitcnt lgkmcnt(0)
s_barrier
s_setprio 2
s_waitcnt vmcnt(2)
v_lshlrev_b32 v44, 16, v136
v_and_b32 v45, s50, v136
v_lshlrev_b32 v46, 16, v137
v_and_b32 v47, s50, v137
v_lshlrev_b32 v48, 16, v138
v_and_b32 v49, s50, v138
v_lshlrev_b32 v50, 16, v139
v_and_b32 v51, s50, v139
v_lshlrev_b32 v52, 16, v140
v_and_b32 v53, s50, v140
v_lshlrev_b32 v54, 16, v141
v_and_b32 v55, s50, v141
v_lshlrev_b32 v56, 16, v142
v_and_b32 v57, s50, v142
v_lshlrev_b32 v58, 16, v143
v_and_b32 v59, s50, v143
v_sub_f32 v44, v44, v166
v_sub_f32 v45, v45, v166
v_sub_f32 v46, v46, v166
v_sub_f32 v47, v47, v166
v_sub_f32 v48, v48, v166
v_sub_f32 v49, v49, v166
v_sub_f32 v50, v50, v166
v_sub_f32 v51, v51, v166
v_sub_f32 v52, v52, v167
v_sub_f32 v53, v53, v167
v_sub_f32 v54, v54, v167
v_sub_f32 v55, v55, v167
v_sub_f32 v56, v56, v167
v_sub_f32 v57, v57, v167
v_sub_f32 v58, v58, v167
v_sub_f32 v59, v59, v167
v_mul_f32 v68, v44, v36
v_mul_f32 v69, v45, v37
v_cvt_pk_bf16_f32 v72, v68, v69
v_mul_f32 v70, v46, v38
v_mul_f32 v71, v47, v39
v_cvt_pk_bf16_f32 v73, v70, v71
v_mul_f32 v68, v48, v40
v_mul_f32 v69, v49, v41
v_cvt_pk_bf16_f32 v74, v68, v69
v_mul_f32 v70, v50, v42
v_mul_f32 v71, v51, v43
v_cvt_pk_bf16_f32 v75, v70, v71
ds_write_b128 v19, v[72:75] offset:16384
v_mul_f32 v68, v52, v36
v_mul_f32 v69, v53, v37
v_cvt_pk_bf16_f32 v76, v68, v69
v_mul_f32 v70, v54, v38
v_mul_f32 v71, v55, v39
v_cvt_pk_bf16_f32 v77, v70, v71
v_mul_f32 v68, v56, v40
v_mul_f32 v69, v57, v41
v_cvt_pk_bf16_f32 v78, v68, v69
v_mul_f32 v70, v58, v42
v_mul_f32 v71, v59, v43
v_cvt_pk_bf16_f32 v79, v70, v71
ds_write_b128 v19, v[76:79] offset:17408
ds_read_b128 v[36:39], v26 offset:2048
ds_read_b128 v[40:43], v26 offset:2064
s_setprio 0
v_pk_add_f32 v[28:29], v[28:29], v[44:45]
v_pk_fma_f32 v[30:31], v[44:45], v[44:45], v[30:31]
v_pk_add_f32 v[32:33], v[32:33], v[52:53]
v_pk_fma_f32 v[34:35], v[52:53], v[52:53], v[34:35]
v_pk_add_f32 v[28:29], v[28:29], v[46:47]
v_pk_fma_f32 v[30:31], v[46:47], v[46:47], v[30:31]
v_pk_add_f32 v[32:33], v[32:33], v[54:55]
v_pk_fma_f32 v[34:35], v[54:55], v[54:55], v[34:35]
v_pk_add_f32 v[28:29], v[28:29], v[48:49]
v_pk_fma_f32 v[30:31], v[48:49], v[48:49], v[30:31]
v_pk_add_f32 v[32:33], v[32:33], v[56:57]
v_pk_fma_f32 v[34:35], v[56:57], v[56:57], v[34:35]
v_pk_add_f32 v[28:29], v[28:29], v[50:51]
v_pk_fma_f32 v[30:31], v[50:51], v[50:51], v[30:31]
v_pk_add_f32 v[32:33], v[32:33], v[58:59]
v_pk_fma_f32 v[34:35], v[58:59], v[58:59], v[34:35]
s_waitcnt lgkmcnt(0)
s_barrier
s_setprio 2
s_waitcnt vmcnt(0)
v_lshlrev_b32 v44, 16, v144
v_and_b32 v45, s50, v144
v_lshlrev_b32 v46, 16, v145
v_and_b32 v47, s50, v145
v_lshlrev_b32 v48, 16, v146
v_and_b32 v49, s50, v146
v_lshlrev_b32 v50, 16, v147
v_and_b32 v51, s50, v147
v_lshlrev_b32 v52, 16, v148
v_and_b32 v53, s50, v148
v_lshlrev_b32 v54, 16, v149
v_and_b32 v55, s50, v149
v_lshlrev_b32 v56, 16, v150
v_and_b32 v57, s50, v150
v_lshlrev_b32 v58, 16, v151
v_and_b32 v59, s50, v151
v_sub_f32 v44, v44, v166
v_sub_f32 v45, v45, v166
v_sub_f32 v46, v46, v166
v_sub_f32 v47, v47, v166
v_sub_f32 v48, v48, v166
v_sub_f32 v49, v49, v166
v_sub_f32 v50, v50, v166
v_sub_f32 v51, v51, v166
v_sub_f32 v52, v52, v167
v_sub_f32 v53, v53, v167
v_sub_f32 v54, v54, v167
v_sub_f32 v55, v55, v167
v_sub_f32 v56, v56, v167
v_sub_f32 v57, v57, v167
v_sub_f32 v58, v58, v167
v_sub_f32 v59, v59, v167
v_mul_f32 v68, v44, v36
v_mul_f32 v69, v45, v37
v_cvt_pk_bf16_f32 v72, v68, v69
v_mul_f32 v70, v46, v38
v_mul_f32 v71, v47, v39
v_cvt_pk_bf16_f32 v73, v70, v71
v_mul_f32 v68, v48, v40
v_mul_f32 v69, v49, v41
v_cvt_pk_bf16_f32 v74, v68, v69
v_mul_f32 v70, v50, v42
v_mul_f32 v71, v51, v43
v_cvt_pk_bf16_f32 v75, v70, v71
ds_write_b128 v19, v[72:75] offset:0
v_mul_f32 v68, v52, v36
v_mul_f32 v69, v53, v37
v_cvt_pk_bf16_f32 v76, v68, v69
v_mul_f32 v70, v54, v38
v_mul_f32 v71, v55, v39
v_cvt_pk_bf16_f32 v77, v70, v71
v_mul_f32 v68, v56, v40
v_mul_f32 v69, v57, v41
v_cvt_pk_bf16_f32 v78, v68, v69
v_mul_f32 v70, v58, v42
v_mul_f32 v71, v59, v43
v_cvt_pk_bf16_f32 v79, v70, v71
ds_write_b128 v19, v[76:79] offset:1024
v_pk_add_f32 v[28:29], v[28:29], v[44:45]
v_pk_fma_f32 v[30:31], v[44:45], v[44:45], v[30:31]
v_pk_add_f32 v[32:33], v[32:33], v[52:53]
v_pk_fma_f32 v[34:35], v[52:53], v[52:53], v[34:35]
v_pk_add_f32 v[28:29], v[28:29], v[46:47]
v_pk_fma_f32 v[30:31], v[46:47], v[46:47], v[30:31]
v_pk_add_f32 v[32:33], v[32:33], v[54:55]
v_pk_fma_f32 v[34:35], v[54:55], v[54:55], v[34:35]
v_pk_add_f32 v[28:29], v[28:29], v[48:49]
v_pk_fma_f32 v[30:31], v[48:49], v[48:49], v[30:31]
v_pk_add_f32 v[32:33], v[32:33], v[56:57]
v_pk_fma_f32 v[34:35], v[56:57], v[56:57], v[34:35]
v_pk_add_f32 v[28:29], v[28:29], v[50:51]
v_pk_fma_f32 v[30:31], v[50:51], v[50:51], v[30:31]
v_pk_add_f32 v[32:33], v[32:33], v[58:59]
v_pk_fma_f32 v[34:35], v[58:59], v[58:59], v[34:35]
s_waitcnt vmcnt(0)
s_waitcnt lgkmcnt(0)
s_barrier
s_setprio 3
L_pstats:
s_lshl_b32 s48, s47, 6
s_add_u32 s48, s48, 128640
v_bfe_u32 v4, v1, 2, 4
v_lshlrev_b32 v4, 3, v4
v_add_u32 v4, s48, v4
v_cmp_gt_u32 vcc, 32, v1
v_add_f32 v28, v28, v29
v_add_f32 v32, v32, v33
v_add_f32 v30, v30, v31
v_add_f32 v34, v34, v35
v_cndmask_b32 v166, v167, v166, vcc
s_nop 0
v_permlane32_swap_b32 v28, v32
v_permlane32_swap_b32 v30, v34
s_nop 1
v_add_f32 v28, v28, v32
v_add_f32 v30, v30, v34
s_nop 1
v_add_f32_dpp v28, v28, v28 quad_perm:[1,0,3,2] row_mask:0xf bank_mask:0xf
v_add_f32_dpp v30, v30, v30 quad_perm:[1,0,3,2] row_mask:0xf bank_mask:0xf
s_nop 1
v_add_f32_dpp v28, v28, v28 quad_perm:[2,3,0,1] row_mask:0xf bank_mask:0xf
v_add_f32_dpp v30, v30, v30 quad_perm:[2,3,0,1] row_mask:0xf bank_mask:0xf
s_nop 1
v_mul_f32 v28, 0x3ae38e39, v28
v_mul_f32 v30, 0x3ae38e39, v30
v_fma_f32 v30, -v28, v28, v30
v_add_f32 v28, v28, v166
v_max_f32 v30, 0, v30
v_cvt_pk_bf16_f32 v32, v28, v30
v_and_b32 v30, s50, v32
v_lshlrev_b32 v28, 16, v32
v_add_f32 v30, 0x3727c5ac, v30
v_sub_f32 v28, v166, v28
v_cvt_pk_bf16_f32 v32, v30, v30
v_and_b32 v30, s50, v32
v_sqrt_f32 v30, v30
s_nop 0
v_cvt_pk_bf16_f32 v32, v30, v30
v_and_b32 v30, s50, v32
v_rcp_f32 v152, v30
s_nop 0
v_mul_f32 v153, v28, v152
s_cmp_ge_u32 s36, 4
s_cselect_b32 exec_hi, -1, 0
ds_write_b64 v4, v[152:153]
s_mov_b64 exec, -1
s_waitcnt lgkmcnt(0)
s_barrier
s_setprio 0
s_mov_b32 s32, s12
s_mov_b32 s33, s13
s_mov_b32 s34, 9437184
s_mov_b32 s35, 0x20000
s_mov_b32 s58, 73728
s_barrier
s_cmp_ge_u32 s36, 4
s_cbranch_scc1 L_stB
ds_read2_b64 v[44:47], v20 offset0:0 offset1:1
ds_read2_b64 v[48:51], v21 offset0:0 offset1:1
ds_read2_b64 v[52:55], v22 offset0:0 offset1:1
s_waitcnt lgkmcnt(2)
buffer_store_dwordx4 v[44:47], v23, s[32:35], 0 offen nt
s_waitcnt lgkmcnt(1)
buffer_store_dwordx4 v[48:51], v24, s[32:35], 0 offen nt
s_waitcnt lgkmcnt(0)
buffer_store_dwordx4 v[52:55], v25, s[32:35], 0 offen nt
v_add_u32 v20, 26112, v20
v_add_u32 v21, 26112, v21
v_add_u32 v22, 26112, v22
s_barrier
s_barrier
ds_read2_b64 v[56:59], v20 offset0:0 offset1:1
ds_read2_b64 v[60:63], v21 offset0:0 offset1:1
ds_read2_b64 v[64:67], v22 offset0:0 offset1:1
s_waitcnt lgkmcnt(2)
buffer_store_dwordx4 v[56:59], v23, s[32:35], s58 offen nt
s_waitcnt lgkmcnt(1)
buffer_store_dwordx4 v[60:63], v24, s[32:35], s58 offen nt
s_waitcnt lgkmcnt(0)
buffer_store_dwordx4 v[64:67], v25, s[32:35], s58 offen nt
s_branch L_fin
L_stB:
s_cmp_eq_u32 s36, 4
s_cbranch_scc0 L_st3
ds_read2_b64 v[56:59], v164 offset0:0 offset1:1
s_waitcnt lgkmcnt(0)
buffer_store_dwordx4 v[56:59], v165, s[32:35], 0 offen nt
L_st3:
s_barrier
ds_read2_b64 v[44:47], v20 offset0:0 offset1:1
ds_read2_b64 v[48:51], v21 offset0:0 offset1:1
ds_read2_b64 v[52:55], v22 offset0:0 offset1:1
s_waitcnt lgkmcnt(2)
buffer_store_dwordx4 v[44:47], v23, s[32:35], 0 offen nt
s_waitcnt lgkmcnt(1)
buffer_store_dwordx4 v[48:51], v24, s[32:35], 0 offen nt
s_waitcnt lgkmcnt(0)
buffer_store_dwordx4 v[52:55], v25, s[32:35], 0 offen nt
s_barrier
s_branch L_fin
L_mfma:
s_setprio 3
v_lshlrev_b32 v5, 4, v1
v_lshlrev_b32 v8, 5, v1
v_mov_b32 v7, 0x40000000
v_cmp_gt_u32 vcc, 36, v1
s_add_u32 s52, s37, 8160
s_mul_i32 s52, s52, 1152
v_cndmask_b32 v148, v7, v8, vcc
s_cmp_eq_u32 s39, 1
s_cselect_b32 s52, s52, 0x40000000
s_mul_i32 s48, s38, 384
s_mul_i32 s49, s39, 18432
s_add_u32 s48, s48, s49
v_add_u32 v6, 0, v1
v_mul_u32_u24 v7, 2731, v6
v_lshrrev_b32 v7, 16, v7
v_mul_u32_u24 v8, 24, v7
v_sub_u32 v6, v6, v8
v_and_b32 v8, 2, v7
v_xor_b32 v6, v6, v8
v_mul_u32_u24 v7, 1152, v7
v_lshl_add_u32 v6, v6, 4, v7
v_add_u32 v152, s48, v6
v_xor_b32 v6, 64, v152
v_add_u32 v155, 9216, v6
v_add_u32 v6, 64, v1
v_mul_u32_u24 v7, 2731, v6
v_lshrrev_b32 v7, 16, v7
v_mul_u32_u24 v8, 24, v7
v_sub_u32 v6, v6, v8
v_and_b32 v8, 2, v7
v_xor_b32 v6, v6, v8
v_mul_u32_u24 v7, 1152, v7
v_lshl_add_u32 v6, v6, 4, v7
v_add_u32 v153, s48, v6
v_xor_b32 v6, 64, v153
v_add_u32 v156, 9216, v6
v_add_u32 v6, 128, v1
v_mul_u32_u24 v7, 2731, v6
v_lshrrev_b32 v7, 16, v7
v_mul_u32_u24 v8, 24, v7
v_sub_u32 v6, v6, v8
v_and_b32 v8, 2, v7
v_xor_b32 v6, v6, v8
v_mul_u32_u24 v7, 1152, v7
v_lshl_add_u32 v6, v6, 4, v7
v_add_u32 v154, s48, v6
v_xor_b32 v6, 64, v154
v_add_u32 v157, 9216, v6
s_waitcnt lgkmcnt(0)
s_mov_b32 s16, s4
s_mov_b32 s17, s5
s_mov_b32 s18, 9437184
s_mov_b32 s19, 0x20000
s_mov_b32 s24, s6
s_mov_b32 s25, s7
s_mov_b32 s26, 1152
s_mov_b32 s27, 0x20000
s_mov_b32 s28, s8
s_mov_b32 s29, s9
s_mov_b32 s30, 1152
s_mov_b32 s31, 0x20000
s_mov_b32 s20, s10
s_mov_b32 s21, s11
s_mov_b32 s22, 663552
s_mov_b32 s23, 0x20000
s_cmp_ge_u32 s39, 2
s_cbranch_scc1 L_mt
buffer_load_dwordx4 v[108:111], v148, s[16:19], s52 offen
buffer_load_dwordx4 v[112:115], v148, s[16:19], s52 offen offset:16
buffer_load_dwordx4 v[100:103], v148, s[24:27], 0 offen
buffer_load_dwordx4 v[104:107], v148, s[24:27], 0 offen offset:16
s_branch L_m1
L_mt:
s_cmp_eq_u32 s39, 2
s_cbranch_scc0 L_mtb
s_mov_b32 m0, 126336
s_nop 0
buffer_load_dwordx4 v5, s[24:27], 0 offen lds
s_mov_b64 exec, 0xff
buffer_load_dwordx4 v5, s[24:27], 0 offen offset:1024 lds
s_mov_b64 exec, -1
s_branch L_m1
L_mtb:
s_mov_b32 m0, 127488
s_nop 0
buffer_load_dwordx4 v5, s[28:31], 0 offen lds
s_mov_b64 exec, 0xff
buffer_load_dwordx4 v5, s[28:31], 0 offen offset:1024 lds
s_mov_b64 exec, -1
L_m1:
s_mul_i32 s59, s39, 6144
s_mul_i32 s57, s40, 73728
s_add_u32 m0, s59, 0
s_nop 0
buffer_load_dwordx4 v152, s[20:23], s57 offen lds
s_add_u32 m0, s59, 1024
s_nop 0
buffer_load_dwordx4 v153, s[20:23], s57 offen lds
s_add_u32 m0, s59, 2048
s_nop 0
buffer_load_dwordx4 v154, s[20:23], s57 offen lds
s_add_u32 m0, s59, 3072
s_nop 0
buffer_load_dwordx4 v155, s[20:23], s57 offen lds
s_add_u32 m0, s59, 4096
s_nop 0
buffer_load_dwordx4 v156, s[20:23], s57 offen lds
s_add_u32 m0, s59, 5120
s_nop 0
buffer_load_dwordx4 v157, s[20:23], s57 offen lds
s_setprio 0
v_lshrrev_b32 v2, 4, v1
v_bfe_u32 v3, v1, 2, 2
v_lshl_add_u32 v4, v2, 3, v3
v_mul_u32_u24 v4, 384, v4
v_and_b32 v6, 2, v3
v_and_b32 v7, 1, v2
v_lshl_or_b32 v6, v7, 2, v6
v_bfe_u32 v7, v1, 1, 1
s_lshl_b32 s48, s39, 1
v_add_u32 v7, s48, v7
v_xor_b32 v6, v6, v7
v_lshl_add_u32 v4, v6, 4, v4
v_and_b32 v7, 1, v1
v_lshl_add_u32 v11, v7, 3, v4
v_and_b32 v3, 7, v1
v_lshrrev_b32 v4, 1, v3
v_and_b32 v4, 2, v4
v_xor_b32 v4, v4, v2
v_lshl_add_u32 v4, v3, 2, v4
v_lshlrev_b32 v4, 4, v4
v_bfe_u32 v6, v1, 3, 1
v_lshl_add_u32 v4, v6, 10, v4
v_add_u32 v13, 131072, v4
v_and_b32 v3, 15, v1
v_min_u32 v4, 2, v3
v_mul_u32_u24 v4, 1152, v4
v_lshl_add_u32 v4, v2, 4, v4
v_add_u32 v14, 125184, v4
v_lshlrev_b32 v8, 3, v3
v_add_u32 v8, 128640, v8
v_mul_u32_u24 v9, 408, v3
v_lshl_add_u32 v9, v2, 3, v9
s_lshl_b32 s48, s39, 5
v_add_u32 v9, s48, v9
v_mov_b32 v12, v11
s_lshl_b32 s48, s40, 7
v_add_u32 v15, s48, v14
v_mov_b32 v16, 0
v_mov_b32 v17, 0
v_mov_b32 v18, 0
v_mov_b32 v19, 0
v_mov_b32 v20, 0
v_mov_b32 v21, 0
v_mov_b32 v22, 0
v_mov_b32 v23, 0
v_mov_b32 v24, 0
v_mov_b32 v25, 0
v_mov_b32 v26, 0
v_mov_b32 v27, 0
v_mov_b32 v28, 0
v_mov_b32 v29, 0
v_mov_b32 v30, 0
v_mov_b32 v31, 0
v_mov_b32 v32, 0
v_mov_b32 v33, 0
v_mov_b32 v34, 0
v_mov_b32 v35, 0
v_mov_b32 v36, 0
v_mov_b32 v37, 0
v_mov_b32 v38, 0
v_mov_b32 v39, 0
v_mov_b32 v40, 0
v_mov_b32 v41, 0
v_mov_b32 v42, 0
v_mov_b32 v43, 0
v_mov_b32 v44, 0
v_mov_b32 v45, 0
v_mov_b32 v46, 0
v_mov_b32 v47, 0
v_mov_b32 v48, 0
v_mov_b32 v49, 0
v_mov_b32 v50, 0
v_mov_b32 v51, 0
v_mov_b32 v52, 0
v_mov_b32 v53, 0
v_mov_b32 v54, 0
v_mov_b32 v55, 0
v_mov_b32 v56, 0
v_mov_b32 v57, 0
v_mov_b32 v58, 0
v_mov_b32 v59, 0
v_mov_b32 v60, 0
v_mov_b32 v61, 0
v_mov_b32 v62, 0
v_mov_b32 v63, 0
v_mov_b32 v64, 0
v_mov_b32 v65, 0
v_mov_b32 v66, 0
v_mov_b32 v67, 0
v_mov_b32 v68, 0
v_mov_b32 v69, 0
v_mov_b32 v70, 0
v_mov_b32 v71, 0
v_mov_b32 v72, 0
v_mov_b32 v73, 0
v_mov_b32 v74, 0
v_mov_b32 v75, 0
v_mov_b32 v76, 0
v_mov_b32 v77, 0
v_mov_b32 v78, 0
v_mov_b32 v79, 0
v_mov_b32 v80, 0
v_mov_b32 v81, 0
v_mov_b32 v82, 0
v_mov_b32 v83, 0
v_mov_b32 v84, 0
v_mov_b32 v85, 0
v_mov_b32 v86, 0
v_mov_b32 v87, 0
v_mov_b32 v88, 0
v_mov_b32 v89, 0
v_mov_b32 v90, 0
v_mov_b32 v91, 0
v_mov_b32 v92, 0
v_mov_b32 v93, 0
v_mov_b32 v94, 0
v_mov_b32 v95, 0
v_mov_b32 v96, 0
v_mov_b32 v97, 0
v_mov_b32 v98, 0
v_mov_b32 v99, 0
s_setprio 3
s_cmp_ge_u32 s39, 2
s_cbranch_scc1 L_m3
s_waitcnt vmcnt(6)
v_lshlrev_b32 v116, 16, v100
v_and_b32 v117, s50, v100
v_lshlrev_b32 v118, 16, v101
v_and_b32 v119, s50, v101
v_lshlrev_b32 v120, 16, v102
v_and_b32 v121, s50, v102
v_lshlrev_b32 v122, 16, v103
v_and_b32 v123, s50, v103
v_lshlrev_b32 v124, 16, v104
v_and_b32 v125, s50, v104
v_lshlrev_b32 v126, 16, v105
v_and_b32 v127, s50, v105
v_lshlrev_b32 v128, 16, v106
v_and_b32 v129, s50, v106
v_lshlrev_b32 v130, 16, v107
v_and_b32 v131, s50, v107
s_cmp_eq_u32 s39, 1
s_cbranch_scc1 L_mx
v_lshlrev_b32 v6, 1, v148
v_add_u32 v6, 122880, v6
s_mov_b32 exec_hi, 0xf
ds_write_b128 v6, v[116:119] offset:0
ds_write_b128 v6, v[120:123] offset:16
ds_write_b128 v6, v[124:127] offset:32
ds_write_b128 v6, v[128:131] offset:48
s_mov_b64 exec, -1
s_branch L_m3
L_mx:
s_mov_b32 s48, 0x3f803f80
v_mov_b32 v164, 0
v_dot2_f32_bf16 v164, v108, s48, v164
v_dot2_f32_bf16 v164, v109, s48, v164
v_dot2_f32_bf16 v164, v110, s48, v164
v_dot2_f32_bf16 v164, v111, s48, v164
v_dot2_f32_bf16 v164, v112, s48, v164
v_dot2_f32_bf16 v164, v113, s48, v164
v_dot2_f32_bf16 v164, v114, s48, v164
v_dot2_f32_bf16 v164, v115, s48, v164
v_lshlrev_b32 v132, 16, v108
v_and_b32 v133, s50, v108
v_lshlrev_b32 v134, 16, v109
v_and_b32 v135, s50, v109
v_add_f32_dpp v164, v164, v164 quad_perm:[1,0,3,2] row_mask:0xf bank_mask:0xf
v_lshlrev_b32 v136, 16, v110
v_and_b32 v137, s50, v110
v_lshlrev_b32 v138, 16, v111
v_and_b32 v139, s50, v111
v_add_f32_dpp v164, v164, v164 quad_perm:[2,3,0,1] row_mask:0xf bank_mask:0xf
v_mul_f32 v164, 0xbc800000, v164
v_cvt_pk_bf16_f32 v164, v164, v164
v_and_b32 v164, s50, v164
v_lshlrev_b32 v140, 16, v112
v_and_b32 v141, s50, v112
v_lshlrev_b32 v142, 16, v113
v_and_b32 v143, s50, v113
v_readlane_b32 s54, v164, 0
v_lshlrev_b32 v144, 16, v114
v_and_b32 v145, s50, v114
v_lshlrev_b32 v146, 16, v115
v_and_b32 v147, s50, v115
v_mov_b32 v160, 0
v_mov_b32 v161, 0
v_mov_b32 v162, 0
v_mov_b32 v163, 0
v_mov_b32 v164, s54
v_mov_b32 v165, s54
v_add_u32 v7, 125184, v148
s_mov_b32 exec_hi, 0xf
v_pk_add_f32 v[132:133], v[132:133], v[164:165]
v_pk_add_f32 v[134:135], v[134:135], v[164:165]
v_pk_add_f32 v[136:137], v[136:137], v[164:165]
v_pk_add_f32 v[138:139], v[138:139], v[164:165]
v_pk_add_f32 v[140:141], v[140:141], v[164:165]
v_pk_add_f32 v[142:143], v[142:143], v[164:165]
v_pk_add_f32 v[144:145], v[144:145], v[164:165]
v_pk_add_f32 v[146:147], v[146:147], v[164:165]
v_pk_mul_f32 v[116:117], v[132:133], v[116:117]
v_pk_mul_f32 v[118:119], v[134:135], v[118:119]
v_pk_mul_f32 v[120:121], v[136:137], v[120:121]
v_pk_mul_f32 v[122:123], v[138:139], v[122:123]
v_pk_mul_f32 v[124:125], v[140:141], v[124:125]
v_pk_mul_f32 v[126:127], v[142:143], v[126:127]
v_pk_mul_f32 v[128:129], v[144:145], v[128:129]
v_pk_mul_f32 v[130:131], v[146:147], v[130:131]
v_cvt_pk_bf16_f32 v100, v116, v117
v_cvt_pk_bf16_f32 v101, v118, v119
v_cvt_pk_bf16_f32 v102, v120, v121
v_cvt_pk_bf16_f32 v103, v122, v123
v_cvt_pk_bf16_f32 v104, v124, v125
v_cvt_pk_bf16_f32 v105, v126, v127
v_cvt_pk_bf16_f32 v106, v128, v129
v_cvt_pk_bf16_f32 v107, v130, v131
ds_write_b128 v7, v[100:103]
ds_write_b128 v7, v[104:107] offset:16
v_pk_add_f32 v[160:161], v[160:161], v[132:133]
v_pk_fma_f32 v[162:163], v[132:133], v[132:133], v[162:163]
v_pk_add_f32 v[160:161], v[160:161], v[134:135]
v_pk_fma_f32 v[162:163], v[134:135], v[134:135], v[162:163]
v_pk_add_f32 v[160:161], v[160:161], v[136:137]
v_pk_fma_f32 v[162:163], v[136:137], v[136:137], v[162:163]
v_pk_add_f32 v[160:161], v[160:161], v[138:139]
v_pk_fma_f32 v[162:163], v[138:139], v[138:139], v[162:163]
v_pk_add_f32 v[160:161], v[160:161], v[140:141]
v_pk_fma_f32 v[162:163], v[140:141], v[140:141], v[162:163]
v_pk_add_f32 v[160:161], v[160:161], v[142:143]
v_pk_fma_f32 v[162:163], v[142:143], v[142:143], v[162:163]
v_pk_add_f32 v[160:161], v[160:161], v[144:145]
v_pk_fma_f32 v[162:163], v[144:145], v[144:145], v[162:163]
v_pk_add_f32 v[160:161], v[160:161], v[146:147]
v_pk_fma_f32 v[162:163], v[146:147], v[146:147], v[162:163]
s_mov_b64 exec, -1
L_m3:
s_mov_b32 s44, 0
s_mov_b32 s43, 0
s_mul_i32 s57, s41, 73728
s_add_u32 m0, s59, 24576
s_nop 0
buffer_load_dwordx4 v152, s[20:23], s57 offen lds
s_add_u32 m0, s59, 25600
s_nop 0
buffer_load_dwordx4 v153, s[20:23], s57 offen lds
s_add_u32 m0, s59, 26624
s_nop 0
buffer_load_dwordx4 v154, s[20:23], s57 offen lds
s_add_u32 m0, s59, 27648
s_nop 0
buffer_load_dwordx4 v155, s[20:23], s57 offen lds
s_add_u32 m0, s59, 28672
s_nop 0
buffer_load_dwordx4 v156, s[20:23], s57 offen lds
s_add_u32 m0, s59, 29696
s_nop 0
buffer_load_dwordx4 v157, s[20:23], s57 offen lds
s_waitcnt vmcnt(6)
s_waitcnt lgkmcnt(0)
s_barrier
ds_read_b64_tr_b16 v[100:101], v12 offset:0
ds_read_b64_tr_b16 v[102:103], v12 offset:1536
ds_read_b64_tr_b16 v[104:105], v12 offset:128
ds_read_b64_tr_b16 v[106:107], v12 offset:1664
ds_read_b64_tr_b16 v[108:109], v12 offset:256
ds_read_b64_tr_b16 v[110:111], v12 offset:1792
ds_read_b128 v[124:127], v15 offset:0
ds_read_b128 v[128:131], v13 offset:0
ds_read_b128 v[132:135], v13 offset:2048
ds_read_b128 v[136:139], v13 offset:4096
ds_read_b128 v[140:143], v13 offset:6144
ds_read_b128 v[144:147], v13 offset:8192
ds_read_b128 v[148:151], v13 offset:10240
s_cmp_lg_u32 s39, 1
s_cbranch_scc1 L_xt
v_add_f32 v160, v160, v161
v_add_f32 v162, v162, v163
v_sub_f32 v164, 0, v164
s_nop 1
v_add_f32_dpp v160, v160, v160 quad_perm:[1,0,3,2] row_mask:0xf bank_mask:0xf
v_add_f32_dpp v162, v162, v162 quad_perm:[1,0,3,2] row_mask:0xf bank_mask:0xf
s_nop 1
v_add_f32_dpp v160, v160, v160 quad_perm:[2,3,0,1] row_mask:0xf bank_mask:0xf
v_add_f32_dpp v162, v162, v162 quad_perm:[2,3,0,1] row_mask:0xf bank_mask:0xf
s_nop 1
v_add_f32_dpp v160, v160, v160 row_half_mirror row_mask:0xf bank_mask:0xf
v_add_f32_dpp v162, v162, v162 row_half_mirror row_mask:0xf bank_mask:0xf
s_nop 1
v_add_f32_dpp v160, v160, v160 row_mirror row_mask:0xf bank_mask:0xf
v_add_f32_dpp v162, v162, v162 row_mirror row_mask:0xf bank_mask:0xf
v_mov_b32 v161, v160
v_mov_b32 v163, v162
s_nop 1
v_permlane16_swap_b32 v160, v161
v_permlane16_swap_b32 v162, v163
s_nop 1
v_add_f32 v160, v160, v161
v_add_f32 v162, v162, v163
v_mov_b32 v161, v160
v_mov_b32 v163, v162
s_nop 1
v_permlane32_swap_b32 v160, v161
v_permlane32_swap_b32 v162, v163
s_nop 1
v_add_f32 v160, v160, v161
v_add_f32 v162, v162, v163
v_mul_f32 v160, 0x3ae38e39, v160
v_mul_f32 v162, 0x3ae38e39, v162
v_fma_f32 v162, -v160, v160, v162
v_add_f32 v160, v160, v164
v_max_f32 v162, 0, v162
v_cvt_pk_bf16_f32 v161, v160, v162
v_and_b32 v162, s50, v161
v_lshlrev_b32 v160, 16, v161
v_add_f32 v162, 0x3727c5ac, v162
v_sub_f32 v160, v164, v160
v_cvt_pk_bf16_f32 v161, v162, v162
v_and_b32 v162, s50, v161
v_sqrt_f32 v162, v162
s_nop 0
v_cvt_pk_bf16_f32 v161, v162, v162
v_and_b32 v162, s50, v161
v_rcp_f32 v166, v162
s_nop 0
v_mul_f32 v167, v160, v166
v_mov_b32 v6, 129408
ds_write_b64 v6, v[166:167]
L_xt:
s_waitcnt lgkmcnt(0)
s_branch L_mmid
L_mloop:
s_waitcnt vmcnt(0)
s_waitcnt lgkmcnt(0)
s_barrier
v_mfma_f32_16x16x32_bf16 v[40:43], v[112:115], v[136:139], v[40:43]
ds_read_b64_tr_b16 v[100:101], v12 offset:0
ds_read_b64_tr_b16 v[102:103], v12 offset:1536
v_mfma_f32_16x16x32_bf16 v[44:47], v[116:119], v[136:139], v[44:47]
ds_read_b128 v[124:127], v15 offset:0
ds_read_b64_tr_b16 v[104:105], v12 offset:128
v_mfma_f32_16x16x32_bf16 v[48:51], v[120:123], v[136:139], v[48:51]
ds_read_b64_tr_b16 v[106:107], v12 offset:1664
ds_read_b64_tr_b16 v[108:109], v12 offset:256
v_mfma_f32_16x16x32_bf16 v[52:55], v[112:115], v[140:143], v[52:55]
ds_read_b64_tr_b16 v[110:111], v12 offset:1792
v_mfma_f32_16x16x32_bf16 v[56:59], v[116:119], v[140:143], v[56:59]
ds_read_b128 v[128:131], v13 offset:0
v_mfma_f32_16x16x32_bf16 v[60:63], v[120:123], v[140:143], v[60:63]
ds_read_b128 v[132:135], v13 offset:2048
v_mfma_f32_16x16x32_bf16 v[64:67], v[112:115], v[144:147], v[64:67]
ds_read_b128 v[136:139], v13 offset:4096
v_mfma_f32_16x16x32_bf16 v[68:71], v[116:119], v[144:147], v[68:71]
ds_read_b128 v[140:143], v13 offset:6144
v_mfma_f32_16x16x32_bf16 v[72:75], v[120:123], v[144:147], v[72:75]
v_mfma_f32_16x16x32_bf16 v[76:79], v[112:115], v[148:151], v[76:79]
ds_read_b128 v[144:147], v13 offset:8192
v_mfma_f32_16x16x32_bf16 v[80:83], v[116:119], v[148:151], v[80:83]
v_mfma_f32_16x16x32_bf16 v[84:87], v[120:123], v[148:151], v[84:87]
ds_read_b128 v[148:151], v13 offset:10240
L_mmid:
s_waitcnt lgkmcnt(10)
v_mfma_f32_16x16x32_bf16 v[88:91], v[100:103], v[124:127], v[88:91]
ds_read_b64_tr_b16 v[112:113], v12 offset:12288
s_add_u32 s44, s44, 24576
s_waitcnt lgkmcnt(9)
v_mfma_f32_16x16x32_bf16 v[92:95], v[104:107], v[124:127], v[92:95]
ds_read_b64_tr_b16 v[114:115], v12 offset:13824
s_cmp_ge_u32 s44, 122880
s_waitcnt lgkmcnt(8)
v_mfma_f32_16x16x32_bf16 v[96:99], v[108:111], v[124:127], v[96:99]
ds_read_b64_tr_b16 v[116:117], v12 offset:12416
s_cselect_b32 s44, 0, s44
s_waitcnt lgkmcnt(8)
v_mfma_f32_16x16x32_bf16 v[16:19], v[100:103], v[128:131], v[16:19]
ds_read_b64_tr_b16 v[118:119], v12 offset:13952
s_add_u32 s43, s43, 1
v_mfma_f32_16x16x32_bf16 v[20:23], v[104:107], v[128:131], v[20:23]
ds_read_b64_tr_b16 v[120:121], v12 offset:12544
v_mfma_f32_16x16x32_bf16 v[24:27], v[108:111], v[128:131], v[24:27]
ds_read_b64_tr_b16 v[122:123], v12 offset:14080
s_waitcnt lgkmcnt(10)
v_mfma_f32_16x16x32_bf16 v[28:31], v[100:103], v[132:135], v[28:31]
ds_read_b128 v[124:127], v15 offset:64
v_mfma_f32_16x16x32_bf16 v[32:35], v[104:107], v[132:135], v[32:35]
ds_read_b128 v[128:131], v13 offset:512
v_mfma_f32_16x16x32_bf16 v[36:39], v[108:111], v[132:135], v[36:39]
s_waitcnt lgkmcnt(11)
v_mfma_f32_16x16x32_bf16 v[40:43], v[100:103], v[136:139], v[40:43]
ds_read_b128 v[132:135], v13 offset:2560
v_mfma_f32_16x16x32_bf16 v[44:47], v[104:107], v[136:139], v[44:47]
v_mfma_f32_16x16x32_bf16 v[48:51], v[108:111], v[136:139], v[48:51]
s_waitcnt lgkmcnt(11)
v_mfma_f32_16x16x32_bf16 v[52:55], v[100:103], v[140:143], v[52:55]
ds_read_b128 v[136:139], v13 offset:4608
v_mfma_f32_16x16x32_bf16 v[56:59], v[104:107], v[140:143], v[56:59]
v_mfma_f32_16x16x32_bf16 v[60:63], v[108:111], v[140:143], v[60:63]
s_waitcnt lgkmcnt(11)
v_mfma_f32_16x16x32_bf16 v[64:67], v[100:103], v[144:147], v[64:67]
ds_read_b128 v[140:143], v13 offset:6656
v_mfma_f32_16x16x32_bf16 v[68:71], v[104:107], v[144:147], v[68:71]
v_mfma_f32_16x16x32_bf16 v[72:75], v[108:111], v[144:147], v[72:75]
s_waitcnt lgkmcnt(11)
v_mfma_f32_16x16x32_bf16 v[76:79], v[100:103], v[148:151], v[76:79]
ds_read_b128 v[144:147], v13 offset:8704
v_mfma_f32_16x16x32_bf16 v[80:83], v[104:107], v[148:151], v[80:83]
v_mfma_f32_16x16x32_bf16 v[84:87], v[108:111], v[148:151], v[84:87]
s_waitcnt lgkmcnt(5)
v_mfma_f32_16x16x32_bf16 v[88:91], v[112:115], v[124:127], v[88:91]
ds_read_b128 v[148:151], v13 offset:10752
v_mfma_f32_16x16x32_bf16 v[92:95], v[116:119], v[124:127], v[92:95]
v_xor_b32 v13, 16384, v13
v_mfma_f32_16x16x32_bf16 v[96:99], v[120:123], v[124:127], v[96:99]
v_add_u32 v12, s44, v11
s_waitcnt lgkmcnt(5)
v_mfma_f32_16x16x32_bf16 v[16:19], v[112:115], v[128:131], v[16:19]
v_add_u32 v15, 128, v15
v_mfma_f32_16x16x32_bf16 v[20:23], v[116:119], v[128:131], v[20:23]
v_mfma_f32_16x16x32_bf16 v[24:27], v[120:123], v[128:131], v[24:27]
s_waitcnt lgkmcnt(4)
v_mfma_f32_16x16x32_bf16 v[28:31], v[112:115], v[132:135], v[28:31]
v_mfma_f32_16x16x32_bf16 v[32:35], v[116:119], v[132:135], v[32:35]
v_mfma_f32_16x16x32_bf16 v[36:39], v[120:123], v[132:135], v[36:39]
s_cmp_lt_u32 s43, 8
s_cbranch_scc1 L_mloop
s_waitcnt lgkmcnt(0)
s_barrier
v_mfma_f32_16x16x32_bf16 v[40:43], v[112:115], v[136:139], v[40:43]
ds_read_b64_tr_b16 v[100:101], v12 offset:0
v_mfma_f32_16x16x32_bf16 v[44:47], v[116:119], v[136:139], v[44:47]
ds_read_b64_tr_b16 v[102:103], v12 offset:1536
v_mfma_f32_16x16x32_bf16 v[48:51], v[120:123], v[136:139], v[48:51]
ds_read_b64_tr_b16 v[104:105], v12 offset:128
v_mfma_f32_16x16x32_bf16 v[52:55], v[112:115], v[140:143], v[52:55]
ds_read_b64_tr_b16 v[106:107], v12 offset:1664
v_mfma_f32_16x16x32_bf16 v[56:59], v[116:119], v[140:143], v[56:59]
ds_read_b64_tr_b16 v[108:109], v12 offset:256
v_mfma_f32_16x16x32_bf16 v[60:63], v[120:123], v[140:143], v[60:63]
ds_read_b64_tr_b16 v[110:111], v12 offset:1792
v_mfma_f32_16x16x32_bf16 v[64:67], v[112:115], v[144:147], v[64:67]
ds_read_b128 v[124:127], v15 offset:0
v_mfma_f32_16x16x32_bf16 v[68:71], v[116:119], v[144:147], v[68:71]
ds_read_b128 v[128:131], v13 offset:0
v_mfma_f32_16x16x32_bf16 v[72:75], v[120:123], v[144:147], v[72:75]
ds_read_b128 v[132:135], v13 offset:2048
v_mfma_f32_16x16x32_bf16 v[76:79], v[112:115], v[148:151], v[76:79]
v_mfma_f32_16x16x32_bf16 v[80:83], v[116:119], v[148:151], v[80:83]
v_mfma_f32_16x16x32_bf16 v[84:87], v[120:123], v[148:151], v[84:87]
s_waitcnt lgkmcnt(2)
v_mfma_f32_16x16x32_bf16 v[88:91], v[100:103], v[124:127], v[88:91]
ds_read_b64_tr_b16 v[112:113], v12 offset:12288
v_mfma_f32_16x16x32_bf16 v[92:95], v[104:107], v[124:127], v[92:95]
ds_read_b64_tr_b16 v[114:115], v12 offset:13824
v_mfma_f32_16x16x32_bf16 v[96:99], v[108:111], v[124:127], v[96:99]
ds_read_b64_tr_b16 v[116:117], v12 offset:12416
s_waitcnt lgkmcnt(4)
v_mfma_f32_16x16x32_bf16 v[16:19], v[100:103], v[128:131], v[16:19]
ds_read_b64_tr_b16 v[118:119], v12 offset:13952
v_mfma_f32_16x16x32_bf16 v[20:23], v[104:107], v[128:131], v[20:23]
ds_read_b64_tr_b16 v[120:121], v12 offset:12544
v_mfma_f32_16x16x32_bf16 v[24:27], v[108:111], v[128:131], v[24:27]
ds_read_b64_tr_b16 v[122:123], v12 offset:14080
s_waitcnt lgkmcnt(6)
v_mfma_f32_16x16x32_bf16 v[28:31], v[100:103], v[132:135], v[28:31]
ds_read_b128 v[136:139], v15 offset:64
v_mfma_f32_16x16x32_bf16 v[32:35], v[104:107], v[132:135], v[32:35]
ds_read_b128 v[124:127], v13 offset:512
v_mfma_f32_16x16x32_bf16 v[36:39], v[108:111], v[132:135], v[36:39]
ds_read_b128 v[128:131], v13 offset:2560
s_waitcnt lgkmcnt(2)
v_mfma_f32_16x16x32_bf16 v[88:91], v[112:115], v[136:139], v[88:91]
ds_read_b128 v[132:135], v13 offset:4096
v_mfma_f32_16x16x32_bf16 v[92:95], v[116:119], v[136:139], v[92:95]
v_mfma_f32_16x16x32_bf16 v[96:99], v[120:123], v[136:139], v[96:99]
s_waitcnt lgkmcnt(2)
v_mfma_f32_16x16x32_bf16 v[16:19], v[112:115], v[124:127], v[16:19]
ds_read_b128 v[136:139], v13 offset:4608
v_mfma_f32_16x16x32_bf16 v[20:23], v[116:119], v[124:127], v[20:23]
v_mfma_f32_16x16x32_bf16 v[24:27], v[120:123], v[124:127], v[24:27]
s_waitcnt lgkmcnt(2)
v_mfma_f32_16x16x32_bf16 v[28:31], v[112:115], v[128:131], v[28:31]
ds_read_b128 v[124:127], v13 offset:6144
v_mov_b32_dpp v152, v88 row_newbcast:1 row_mask:0xf bank_mask:0xf
v_mov_b32_dpp v140, v88 row_newbcast:2 row_mask:0xf bank_mask:0xf
v_mfma_f32_16x16x32_bf16 v[32:35], v[116:119], v[128:131], v[32:35]
v_mov_b32_dpp v153, v89 row_newbcast:1 row_mask:0xf bank_mask:0xf
v_mov_b32_dpp v141, v89 row_newbcast:2 row_mask:0xf bank_mask:0xf
v_mfma_f32_16x16x32_bf16 v[36:39], v[120:123], v[128:131], v[36:39]
v_mov_b32_dpp v154, v90 row_newbcast:1 row_mask:0xf bank_mask:0xf
v_mov_b32_dpp v142, v90 row_newbcast:2 row_mask:0xf bank_mask:0xf
s_waitcnt lgkmcnt(2)
v_mfma_f32_16x16x32_bf16 v[40:43], v[100:103], v[132:135], v[40:43]
ds_read_b128 v[128:131], v13 offset:6656
v_mov_b32_dpp v155, v91 row_newbcast:1 row_mask:0xf bank_mask:0xf
v_mov_b32_dpp v143, v91 row_newbcast:2 row_mask:0xf bank_mask:0xf
v_mfma_f32_16x16x32_bf16 v[44:47], v[104:107], v[132:135], v[44:47]
v_mov_b32_dpp v156, v92 row_newbcast:1 row_mask:0xf bank_mask:0xf
v_mov_b32_dpp v144, v92 row_newbcast:2 row_mask:0xf bank_mask:0xf
v_mfma_f32_16x16x32_bf16 v[48:51], v[108:111], v[132:135], v[48:51]
v_mov_b32_dpp v157, v93 row_newbcast:1 row_mask:0xf bank_mask:0xf
v_mov_b32_dpp v145, v93 row_newbcast:2 row_mask:0xf bank_mask:0xf
s_waitcnt lgkmcnt(2)
v_mfma_f32_16x16x32_bf16 v[40:43], v[112:115], v[136:139], v[40:43]
ds_read_b128 v[132:135], v13 offset:8192
v_mov_b32_dpp v158, v94 row_newbcast:1 row_mask:0xf bank_mask:0xf
v_mov_b32_dpp v146, v94 row_newbcast:2 row_mask:0xf bank_mask:0xf
v_mfma_f32_16x16x32_bf16 v[44:47], v[116:119], v[136:139], v[44:47]
v_mov_b32_dpp v159, v95 row_newbcast:1 row_mask:0xf bank_mask:0xf
v_mov_b32_dpp v147, v95 row_newbcast:2 row_mask:0xf bank_mask:0xf
v_mfma_f32_16x16x32_bf16 v[48:51], v[120:123], v[136:139], v[48:51]
s_barrier
ds_read_b64 v[2:3], v8 offset:768
ds_read_b64 v[4:5], v8 offset:0
ds_read_b64 v[6:7], v8 offset:128
v_mov_b32_dpp v160, v96 row_newbcast:1 row_mask:0xf bank_mask:0xf
v_mov_b32_dpp v148, v96 row_newbcast:2 row_mask:0xf bank_mask:0xf
s_waitcnt lgkmcnt(5)
v_mfma_f32_16x16x32_bf16 v[52:55], v[100:103], v[124:127], v[52:55]
ds_read_b128 v[136:139], v13 offset:8704
v_mov_b32_dpp v161, v97 row_newbcast:1 row_mask:0xf bank_mask:0xf
v_mov_b32_dpp v149, v97 row_newbcast:2 row_mask:0xf bank_mask:0xf
v_mfma_f32_16x16x32_bf16 v[56:59], v[104:107], v[124:127], v[56:59]
v_mov_b32_dpp v162, v98 row_newbcast:1 row_mask:0xf bank_mask:0xf
v_mov_b32_dpp v150, v98 row_newbcast:2 row_mask:0xf bank_mask:0xf
v_mfma_f32_16x16x32_bf16 v[60:63], v[108:111], v[124:127], v[60:63]
v_mov_b32_dpp v163, v99 row_newbcast:1 row_mask:0xf bank_mask:0xf
v_mov_b32_dpp v151, v99 row_newbcast:2 row_mask:0xf bank_mask:0xf
s_waitcnt lgkmcnt(5)
v_mfma_f32_16x16x32_bf16 v[52:55], v[112:115], v[128:131], v[52:55]
ds_read_b128 v[124:127], v13 offset:10240
s_waitcnt lgkmcnt(4)
v_fma_f32 v164, v152, v3, v140
v_fma_f32 v165, v153, v3, v141
v_mfma_f32_16x16x32_bf16 v[56:59], v[116:119], v[128:131], v[56:59]
v_fma_f32 v166, v154, v3, v142
v_fma_f32 v167, v155, v3, v143
v_mfma_f32_16x16x32_bf16 v[60:63], v[120:123], v[128:131], v[60:63]
v_fmac_f32 v164, v88, v2
v_fmac_f32 v165, v89, v2
v_mfma_f32_16x16x32_bf16 v[64:67], v[100:103], v[132:135], v[64:67]
ds_read_b128 v[128:131], v13 offset:10752
v_fmac_f32 v166, v90, v2
v_fmac_f32 v167, v91, v2
v_mfma_f32_16x16x32_bf16 v[68:71], v[104:107], v[132:135], v[68:71]
v_cvt_pk_bf16_f32 v88, v164, v165
v_cvt_pk_bf16_f32 v89, v166, v167
v_mfma_f32_16x16x32_bf16 v[72:75], v[108:111], v[132:135], v[72:75]
ds_write_b64 v9, v[88:89] offset:39168
v_fma_f32 v164, v156, v3, v144
v_fma_f32 v165, v157, v3, v145
s_waitcnt lgkmcnt(3)
v_mfma_f32_16x16x32_bf16 v[64:67], v[112:115], v[136:139], v[64:67]
v_fma_f32 v166, v158, v3, v146
v_fma_f32 v167, v159, v3, v147
v_mfma_f32_16x16x32_bf16 v[68:71], v[116:119], v[136:139], v[68:71]
v_fmac_f32 v164, v92, v2
v_fmac_f32 v165, v93, v2
v_mfma_f32_16x16x32_bf16 v[72:75], v[120:123], v[136:139], v[72:75]
v_fmac_f32 v166, v94, v2
v_fmac_f32 v167, v95, v2
s_waitcnt lgkmcnt(2)
v_mfma_f32_16x16x32_bf16 v[76:79], v[100:103], v[124:127], v[76:79]
v_cvt_pk_bf16_f32 v92, v164, v165
v_cvt_pk_bf16_f32 v93, v166, v167
v_mfma_f32_16x16x32_bf16 v[80:83], v[104:107], v[124:127], v[80:83]
ds_write_b64 v9, v[92:93] offset:39296
v_fma_f32 v164, v160, v3, v148
v_fma_f32 v165, v161, v3, v149
v_mfma_f32_16x16x32_bf16 v[84:87], v[108:111], v[124:127], v[84:87]
v_fma_f32 v166, v162, v3, v150
v_fma_f32 v167, v163, v3, v151
s_waitcnt lgkmcnt(2)
v_mfma_f32_16x16x32_bf16 v[76:79], v[112:115], v[128:131], v[76:79]
v_fmac_f32 v164, v96, v2
v_fmac_f32 v165, v97, v2
v_mfma_f32_16x16x32_bf16 v[80:83], v[116:119], v[128:131], v[80:83]
v_fmac_f32 v166, v98, v2
v_fmac_f32 v167, v99, v2
v_mfma_f32_16x16x32_bf16 v[84:87], v[120:123], v[128:131], v[84:87]
v_cvt_pk_bf16_f32 v96, v164, v165
v_cvt_pk_bf16_f32 v97, v166, v167
ds_write_b64 v9, v[96:97] offset:39424
ds_read_b64 v[2:3], v8 offset:256
s_nop 7
v_pk_fma_f32 v[112:113], v[152:153], v[4:5], v[140:141] op_sel:[0,1,0] op_sel_hi:[1,1,1]
v_pk_fma_f32 v[114:115], v[154:155], v[4:5], v[142:143] op_sel:[0,1,0] op_sel_hi:[1,1,1]
v_pk_fma_f32 v[116:117], v[156:157], v[4:5], v[144:145] op_sel:[0,1,0] op_sel_hi:[1,1,1]
v_pk_fma_f32 v[118:119], v[158:159], v[4:5], v[146:147] op_sel:[0,1,0] op_sel_hi:[1,1,1]
v_pk_fma_f32 v[120:121], v[160:161], v[4:5], v[148:149] op_sel:[0,1,0] op_sel_hi:[1,1,1]
v_pk_fma_f32 v[122:123], v[162:163], v[4:5], v[150:151] op_sel:[0,1,0] op_sel_hi:[1,1,1]
v_pk_fma_f32 v[112:113], v[16:17], v[4:5], v[112:113] op_sel:[0,0,0] op_sel_hi:[1,0,1]
v_pk_fma_f32 v[114:115], v[18:19], v[4:5], v[114:115] op_sel:[0,0,0] op_sel_hi:[1,0,1]
v_pk_fma_f32 v[116:117], v[20:21], v[4:5], v[116:117] op_sel:[0,0,0] op_sel_hi:[1,0,1]
v_pk_fma_f32 v[118:119], v[22:23], v[4:5], v[118:119] op_sel:[0,0,0] op_sel_hi:[1,0,1]
v_pk_fma_f32 v[120:121], v[24:25], v[4:5], v[120:121] op_sel:[0,0,0] op_sel_hi:[1,0,1]
v_pk_fma_f32 v[122:123], v[26:27], v[4:5], v[122:123] op_sel:[0,0,0] op_sel_hi:[1,0,1]
ds_read_b64 v[4:5], v8 offset:384
v_cvt_pk_bf16_f32 v16, v112, v113
v_cvt_pk_bf16_f32 v17, v114, v115
v_cvt_pk_bf16_f32 v20, v116, v117
v_cvt_pk_bf16_f32 v21, v118, v119
v_cvt_pk_bf16_f32 v24, v120, v121
v_cvt_pk_bf16_f32 v25, v122, v123
v_pk_fma_f32 v[100:101], v[152:153], v[6:7], v[140:141] op_sel:[0,1,0] op_sel_hi:[1,1,1]
v_pk_fma_f32 v[102:103], v[154:155], v[6:7], v[142:143] op_sel:[0,1,0] op_sel_hi:[1,1,1]
ds_write_b64 v9, v[16:17] offset:0
v_pk_fma_f32 v[104:105], v[156:157], v[6:7], v[144:145] op_sel:[0,1,0] op_sel_hi:[1,1,1]
v_pk_fma_f32 v[106:107], v[158:159], v[6:7], v[146:147] op_sel:[0,1,0] op_sel_hi:[1,1,1]
v_pk_fma_f32 v[108:109], v[160:161], v[6:7], v[148:149] op_sel:[0,1,0] op_sel_hi:[1,1,1]
v_pk_fma_f32 v[110:111], v[162:163], v[6:7], v[150:151] op_sel:[0,1,0] op_sel_hi:[1,1,1]
ds_write_b64 v9, v[20:21] offset:128
v_pk_fma_f32 v[100:101], v[28:29], v[6:7], v[100:101] op_sel:[0,0,0] op_sel_hi:[1,0,1]
v_pk_fma_f32 v[102:103], v[30:31], v[6:7], v[102:103] op_sel:[0,0,0] op_sel_hi:[1,0,1]
v_pk_fma_f32 v[104:105], v[32:33], v[6:7], v[104:105] op_sel:[0,0,0] op_sel_hi:[1,0,1]
v_pk_fma_f32 v[106:107], v[34:35], v[6:7], v[106:107] op_sel:[0,0,0] op_sel_hi:[1,0,1]
ds_write_b64 v9, v[24:25] offset:256
v_pk_fma_f32 v[108:109], v[36:37], v[6:7], v[108:109] op_sel:[0,0,0] op_sel_hi:[1,0,1]
v_pk_fma_f32 v[110:111], v[38:39], v[6:7], v[110:111] op_sel:[0,0,0] op_sel_hi:[1,0,1]
ds_read_b64 v[6:7], v8 offset:512
v_cvt_pk_bf16_f32 v28, v100, v101
v_cvt_pk_bf16_f32 v29, v102, v103
v_cvt_pk_bf16_f32 v32, v104, v105
v_cvt_pk_bf16_f32 v33, v106, v107
v_cvt_pk_bf16_f32 v36, v108, v109
v_cvt_pk_bf16_f32 v37, v110, v111
s_waitcnt lgkmcnt(5)
v_pk_fma_f32 v[112:113], v[152:153], v[2:3], v[140:141] op_sel:[0,1,0] op_sel_hi:[1,1,1]
v_pk_fma_f32 v[114:115], v[154:155], v[2:3], v[142:143] op_sel:[0,1,0] op_sel_hi:[1,1,1]
ds_write_b64 v9, v[28:29] offset:6528
v_pk_fma_f32 v[116:117], v[156:157], v[2:3], v[144:145] op_sel:[0,1,0] op_sel_hi:[1,1,1]
v_pk_fma_f32 v[118:119], v[158:159], v[2:3], v[146:147] op_sel:[0,1,0] op_sel_hi:[1,1,1]
v_pk_fma_f32 v[120:121], v[160:161], v[2:3], v[148:149] op_sel:[0,1,0] op_sel_hi:[1,1,1]
v_pk_fma_f32 v[122:123], v[162:163], v[2:3], v[150:151] op_sel:[0,1,0] op_sel_hi:[1,1,1]
ds_write_b64 v9, v[32:33] offset:6656
v_pk_fma_f32 v[112:113], v[40:41], v[2:3], v[112:113] op_sel:[0,0,0] op_sel_hi:[1,0,1]
v_pk_fma_f32 v[114:115], v[42:43], v[2:3], v[114:115] op_sel:[0,0,0] op_sel_hi:[1,0,1]
v_pk_fma_f32 v[116:117], v[44:45], v[2:3], v[116:117] op_sel:[0,0,0] op_sel_hi:[1,0,1]
v_pk_fma_f32 v[118:119], v[46:47], v[2:3], v[118:119] op_sel:[0,0,0] op_sel_hi:[1,0,1]
ds_write_b64 v9, v[36:37] offset:6784
v_pk_fma_f32 v[120:121], v[48:49], v[2:3], v[120:121] op_sel:[0,0,0] op_sel_hi:[1,0,1]
v_pk_fma_f32 v[122:123], v[50:51], v[2:3], v[122:123] op_sel:[0,0,0] op_sel_hi:[1,0,1]
ds_read_b64 v[2:3], v8 offset:640
s_waitcnt lgkmcnt(1)
s_barrier
v_cvt_pk_bf16_f32 v40, v112, v113
v_cvt_pk_bf16_f32 v41, v114, v115
v_cvt_pk_bf16_f32 v44, v116, v117
v_cvt_pk_bf16_f32 v45, v118, v119
v_cvt_pk_bf16_f32 v48, v120, v121
v_cvt_pk_bf16_f32 v49, v122, v123
v_pk_fma_f32 v[100:101], v[152:153], v[4:5], v[140:141] op_sel:[0,1,0] op_sel_hi:[1,1,1]
v_pk_fma_f32 v[102:103], v[154:155], v[4:5], v[142:143] op_sel:[0,1,0] op_sel_hi:[1,1,1]
ds_write_b64 v9, v[40:41] offset:13056
v_pk_fma_f32 v[104:105], v[156:157], v[4:5], v[144:145] op_sel:[0,1,0] op_sel_hi:[1,1,1]
v_pk_fma_f32 v[106:107], v[158:159], v[4:5], v[146:147] op_sel:[0,1,0] op_sel_hi:[1,1,1]
v_pk_fma_f32 v[108:109], v[160:161], v[4:5], v[148:149] op_sel:[0,1,0] op_sel_hi:[1,1,1]
v_pk_fma_f32 v[110:111], v[162:163], v[4:5], v[150:151] op_sel:[0,1,0] op_sel_hi:[1,1,1]
ds_write_b64 v9, v[44:45] offset:13184
v_pk_fma_f32 v[100:101], v[52:53], v[4:5], v[100:101] op_sel:[0,0,0] op_sel_hi:[1,0,1]
v_pk_fma_f32 v[102:103], v[54:55], v[4:5], v[102:103] op_sel:[0,0,0] op_sel_hi:[1,0,1]
v_pk_fma_f32 v[104:105], v[56:57], v[4:5], v[104:105] op_sel:[0,0,0] op_sel_hi:[1,0,1]
v_pk_fma_f32 v[106:107], v[58:59], v[4:5], v[106:107] op_sel:[0,0,0] op_sel_hi:[1,0,1]
ds_write_b64 v9, v[48:49] offset:13312
v_pk_fma_f32 v[108:109], v[60:61], v[4:5], v[108:109] op_sel:[0,0,0] op_sel_hi:[1,0,1]
v_pk_fma_f32 v[110:111], v[62:63], v[4:5], v[110:111] op_sel:[0,0,0] op_sel_hi:[1,0,1]
v_cvt_pk_bf16_f32 v52, v100, v101
v_cvt_pk_bf16_f32 v53, v102, v103
v_cvt_pk_bf16_f32 v56, v104, v105
v_cvt_pk_bf16_f32 v57, v106, v107
v_cvt_pk_bf16_f32 v60, v108, v109
v_cvt_pk_bf16_f32 v61, v110, v111
v_pk_fma_f32 v[112:113], v[152:153], v[6:7], v[140:141] op_sel:[0,1,0] op_sel_hi:[1,1,1]
v_pk_fma_f32 v[114:115], v[154:155], v[6:7], v[142:143] op_sel:[0,1,0] op_sel_hi:[1,1,1]
ds_write_b64 v9, v[52:53] offset:19584
v_pk_fma_f32 v[116:117], v[156:157], v[6:7], v[144:145] op_sel:[0,1,0] op_sel_hi:[1,1,1]
v_pk_fma_f32 v[118:119], v[158:159], v[6:7], v[146:147] op_sel:[0,1,0] op_sel_hi:[1,1,1]
v_pk_fma_f32 v[120:121], v[160:161], v[6:7], v[148:149] op_sel:[0,1,0] op_sel_hi:[1,1,1]
v_pk_fma_f32 v[122:123], v[162:163], v[6:7], v[150:151] op_sel:[0,1,0] op_sel_hi:[1,1,1]
ds_write_b64 v9, v[56:57] offset:19712
v_pk_fma_f32 v[112:113], v[64:65], v[6:7], v[112:113] op_sel:[0,0,0] op_sel_hi:[1,0,1]
v_pk_fma_f32 v[114:115], v[66:67], v[6:7], v[114:115] op_sel:[0,0,0] op_sel_hi:[1,0,1]
v_pk_fma_f32 v[116:117], v[68:69], v[6:7], v[116:117] op_sel:[0,0,0] op_sel_hi:[1,0,1]
v_pk_fma_f32 v[118:119], v[70:71], v[6:7], v[118:119] op_sel:[0,0,0] op_sel_hi:[1,0,1]
ds_write_b64 v9, v[60:61] offset:19840
v_pk_fma_f32 v[120:121], v[72:73], v[6:7], v[120:121] op_sel:[0,0,0] op_sel_hi:[1,0,1]
v_pk_fma_f32 v[122:123], v[74:75], v[6:7], v[122:123] op_sel:[0,0,0] op_sel_hi:[1,0,1]
s_waitcnt lgkmcnt(0)
s_barrier
v_cvt_pk_bf16_f32 v64, v112, v113
v_cvt_pk_bf16_f32 v65, v114, v115
v_cvt_pk_bf16_f32 v68, v116, v117
v_cvt_pk_bf16_f32 v69, v118, v119
v_cvt_pk_bf16_f32 v72, v120, v121
v_cvt_pk_bf16_f32 v73, v122, v123
v_pk_fma_f32 v[100:101], v[152:153], v[2:3], v[140:141] op_sel:[0,1,0] op_sel_hi:[1,1,1]
v_pk_fma_f32 v[102:103], v[154:155], v[2:3], v[142:143] op_sel:[0,1,0] op_sel_hi:[1,1,1]
ds_write_b64 v9, v[64:65] offset:26112
v_pk_fma_f32 v[104:105], v[156:157], v[2:3], v[144:145] op_sel:[0,1,0] op_sel_hi:[1,1,1]
v_pk_fma_f32 v[106:107], v[158:159], v[2:3], v[146:147] op_sel:[0,1,0] op_sel_hi:[1,1,1]
v_pk_fma_f32 v[108:109], v[160:161], v[2:3], v[148:149] op_sel:[0,1,0] op_sel_hi:[1,1,1]
v_pk_fma_f32 v[110:111], v[162:163], v[2:3], v[150:151] op_sel:[0,1,0] op_sel_hi:[1,1,1]
ds_write_b64 v9, v[68:69] offset:26240
v_pk_fma_f32 v[100:101], v[76:77], v[2:3], v[100:101] op_sel:[0,0,0] op_sel_hi:[1,0,1]
v_pk_fma_f32 v[102:103], v[78:79], v[2:3], v[102:103] op_sel:[0,0,0] op_sel_hi:[1,0,1]
v_pk_fma_f32 v[104:105], v[80:81], v[2:3], v[104:105] op_sel:[0,0,0] op_sel_hi:[1,0,1]
v_pk_fma_f32 v[106:107], v[82:83], v[2:3], v[106:107] op_sel:[0,0,0] op_sel_hi:[1,0,1]
ds_write_b64 v9, v[72:73] offset:26368
v_pk_fma_f32 v[108:109], v[84:85], v[2:3], v[108:109] op_sel:[0,0,0] op_sel_hi:[1,0,1]
v_pk_fma_f32 v[110:111], v[86:87], v[2:3], v[110:111] op_sel:[0,0,0] op_sel_hi:[1,0,1]
v_cvt_pk_bf16_f32 v76, v100, v101
v_cvt_pk_bf16_f32 v77, v102, v103
ds_write_b64 v9, v[76:77] offset:32640
v_cvt_pk_bf16_f32 v80, v104, v105
v_cvt_pk_bf16_f32 v81, v106, v107
ds_write_b64 v9, v[80:81] offset:32768
v_cvt_pk_bf16_f32 v84, v108, v109
v_cvt_pk_bf16_f32 v85, v110, v111
ds_write_b64 v9, v[84:85] offset:32896
s_waitcnt lgkmcnt(0)
s_barrier
L_fin:
L_end:
s_endpgm
.section .rodata,"a"
.p2align 6
.amdhsa_kernel standalone__layernorm_linear__sampling_kernel
  .amdhsa_next_free_vgpr 168
  .amdhsa_next_free_sgpr 72
  .amdhsa_accum_offset 168
  .amdhsa_group_segment_fixed_size 0
  .amdhsa_kernarg_size 56
  .amdhsa_user_sgpr_count 2
  .amdhsa_user_sgpr_kernarg_segment_ptr 1
  .amdhsa_system_sgpr_workgroup_id_x 1
.end_amdhsa_kernel
```
